```python
import torch

def _softmax(x, axis=-1):
    return torch.softmax(x, dim=axis)
def _gelu(x):
    return torch.nn.functional.gelu(x, approximate="tanh")
def _silu(x):
    return torch.nn.functional.silu(x)
def _sigmoid(x):
    return torch.sigmoid(x)
def _layernorm(x, axis=-1, eps=1e-5):
    m = x.mean(dim=axis, keepdim=True)
    v = x.var(dim=axis, keepdim=True, unbiased=False)
    return (x - m) / torch.sqrt(v + eps)
def _scatter_add(tgt, idx, src, axis=0):
    return tgt.clone().index_add_(axis, idx, src)
def _segment_sum(src, seg, n):
    out = torch.zeros((n,) + src.shape[1:], dtype=src.dtype)
    return out.index_add_(0, seg, src)
def _pad(x, pw):
    flat = tuple(v for pair in reversed(pw) for v in pair)
    return torch.nn.functional.pad(x, flat)

kernel_name = 'gated_mix__sliding_local_dilated__dense_activation_gelu__prompt'

def setup_inputs():

    _w = (lambda a: (lambda t: t.to(torch.bfloat16) if t.is_floating_point() else t)(torch.as_tensor(a)))
    def _A_setup():
        B, S, D = 1, 2048, 640
        return {
            "x": _w((lambda *s: torch.randn(*s, dtype=torch.bfloat16) * 0.2)(B, S, D)),
            "wqkv": _w((lambda *s: torch.randn(*s, dtype=torch.bfloat16) * 0.2)(D, 3 * D)),
            "wo": _w((lambda *s: torch.randn(*s, dtype=torch.bfloat16) * 0.2)(D, D)),
        }
    _A_in = _A_setup()

    def _B_setup():
        B, S, D, F = 1, 2048, 640, 1728
        return {
            "x": _w((lambda *s: torch.randn(*s, dtype=torch.bfloat16) * 0.2)(B, S, D)),
            "w1": _w((lambda *s: torch.randn(*s, dtype=torch.bfloat16) * 3.2)(D, F) * (D ** -0.5)),
            "b1": _w((lambda *s: torch.randn(*s, dtype=torch.bfloat16) * 3.2)(F) * 0.01),
            "w2": _w((lambda *s: torch.randn(*s, dtype=torch.bfloat16) * 3.2)(F, D) * (F ** -0.5)),
            "b2": _w((lambda *s: torch.randn(*s, dtype=torch.bfloat16) * 3.2)(D) * 0.01),
        }
    _B_in = _B_setup()

    return {
        "A_x": _A_in["x"],
        "A_wqkv": _A_in["wqkv"],
        "A_wo": _A_in["wo"],
        "B_x": _B_in["x"],
        "B_w1": _B_in["w1"],
        "B_b1": _B_in["b1"],
        "B_w2": _B_in["w2"],
        "B_b2": _B_in["b2"],
        "gate_w": _w((lambda *s: torch.randn(*s, dtype=torch.bfloat16) * 0.2)(640) * 16.0),
    }

def reference(A_x, A_wqkv, A_wo, B_x, B_w1, B_b1, B_w2, B_b2, gate_w):
    def _A_ref(x, wqkv, wo):
        B, S, D = x.shape
        H = 32; Dh = D // H
        W, dil = 8, 2
        qkv = (lambda x, *d: x.permute(*d))((x @ wqkv).reshape(B, S, 3, H, Dh), 2, 0, 3, 1, 4)
        q, k, v = qkv[0], qkv[1], qkv[2]
        scale = Dh ** -0.5
        pos = torch.arange(S)
        off = torch.arange(W) * dil
        idx = pos[:, None] - off[None, :]
        mask = idx >= 0
        idx_c = torch.where(mask, idx, 0).reshape(-1)
        kg = k[:, :, idx_c, :].reshape(B, H, S, W, Dh)
        vg = v[:, :, idx_c, :].reshape(B, H, S, W, Dh)
        logits = torch.einsum("bhsd,bhswd->bhsw", q, kg) * scale
        logits = torch.where(mask[None, None, :, :], logits, -1e9)
        attn = _softmax(logits, axis=-1)
        o = torch.einsum("bhsw,bhswd->bhsd", attn, vg)
        return (lambda x, *d: x.permute(*d))(o, 0, 2, 1, 3).reshape(B, S, D) @ wo

    def _B_ref(x, w1, b1, w2, b2):
        h = torch.einsum("bsd,df->bsf", x, w1) + b1
        h = _gelu(h)
        return torch.einsum("bsf,fd->bsd", h, w2) + b2

    x = A_x
    g = _sigmoid((x * gate_w).sum(-1, keepdims=True))
    a = _A_ref(x, A_wqkv, A_wo)
    b = _B_ref(x, B_w1, B_b1, B_w2, B_b2)
    return g * a + (1 - g) * b
```

```asm
; @launch grid=(256,1,1) block=(512,1,1) lds=163840
.amdgcn_target "amdgcn-amd-amdhsa--gfx950"
.text
.p2align 8
.globl gated_mix__sliding_local_dilated__dense_activation_gelu__prompt_kernel
.type gated_mix__sliding_local_dilated__dense_activation_gelu__prompt_kernel,@function
gated_mix__sliding_local_dilated__dense_activation_gelu__prompt_kernel:
    s_cmp_ge_u32 s2, 256
    s_cbranch_scc1 K_END
    s_getpc_b64 s[56:57]
K_PC:
    v_lshlrev_b32 v20, 7, v0
    v_min_u32 v20, K_CODE_END-K_PC-64, v20
    global_load_dword v31, v20, s[56:57]
    s_load_dwordx2 s[4:5], s[0:1], 0
    s_load_dwordx4 s[32:35], s[0:1], 8
    s_load_dwordx4 s[36:39], s[0:1], 32
    s_load_dwordx2 s[52:53], s[0:1], 48
    s_load_dwordx2 s[16:17], s[0:1], 64
    s_load_dwordx4 s[40:43], s[0:1], 80
    s_load_dwordx2 s[28:29], s[0:1], 72
    v_and_b32 v1, 63, v0
    v_lshrrev_b32 v20, 6, v0
    v_and_b32 v15, 255, v0
    v_readfirstlane_b32 s20, v20
    s_and_b32 s48, s2, 7
    s_lshr_b32 s49, s2, 3
    s_and_b32 s51, s48, 3
    s_lshr_b32 s48, s48, 2
    s_lshr_b32 s31, s20, 2
    s_and_b32 s20, s20, 3
    s_lshr_b32 s21, s20, 1
    s_and_b32 s22, s20, 1
    s_cmp_ge_u32 s49, 18
    s_cbranch_scc1 K_HIDX
    s_mov_b32 s23, 0
    s_mul_i32 s48, s48, 9
    s_lshr_b32 s58, s49, 1
    s_add_u32 s24, s48, s58
    s_and_b32 s49, s49, 1
    s_lshl_b32 s51, s51, 1
    s_add_u32 s25, s51, s49
    s_mul_i32 s59, s24, 114
    s_branch K_IDXD
K_HIDX:
    s_mov_b32 s23, 1
    s_sub_u32 s49, s49, 18
    s_mul_i32 s51, s51, 14
    s_add_u32 s49, s49, s51
    s_lshr_b32 s25, s49, 3
    s_and_b32 s49, s49, 7
    s_lshl_b32 s48, s48, 3
    s_add_u32 s24, s48, s49
    s_lshl_b32 s59, s24, 7
K_IDXD:
    s_cmp_eq_u32 s31, 0
    s_cbranch_scc1 K_COMPUTE
    v_lshrrev_b32 v20, 3, v1
    v_and_b32 v21, 7, v1
    v_lshrrev_b32 v22, 4, v1
    s_lshl_b32 s48, s20, 5
    v_add_u32 v23, s48, v20
    v_mul_u32_u24 v23, 1280, v23
    v_xor_b32 v24, v21, v22
    v_xor_b32 v25, 4, v24
    v_lshl_add_u32 v24, v24, 4, v23
    v_lshl_add_u32 v25, v25, 4, v23
    v_add_u32 v2, 0, v24
    v_add_u32 v3, 9216, v25
    v_add_u32 v4, 18432, v24
    v_add_u32 v5, 27648, v25
    s_mul_i32 s26, s59, 1280
    s_mov_b32 s27, 0
    s_cmp_eq_u32 s23, 1
    s_cbranch_scc1 K_HSET
    s_mov_b32 s48, 2185
    v_mul_u32_u24 v20, s48, v1
    v_lshrrev_b32 v20, 16, v20
    v_mul_u32_u24 v21, 30, v20
    v_sub_u32 v21, v1, v21
    s_mov_b32 s48, 6554
    v_mul_u32_u24 v22, s48, v21
    v_lshrrev_b32 v22, 16, v22
    v_mul_u32_u24 v23, 10, v22
    v_sub_u32 v23, v21, v23
    v_mul_u32_u24 v22, 1280, v22
    v_lshl_add_u32 v22, v23, 4, v22
    v_mul_u32_u24 v23, 3840, v20
    v_add_u32 v22, v22, v23
    s_lshr_b32 s48, s20, 1
    s_lshl_b32 s48, s48, 5
    s_and_b32 s49, s20, 1
    s_lshl_b32 s49, s49, 2
    s_add_u32 s48, s48, s49
    s_mul_i32 s48, s48, 3840
    s_mul_i32 s49, s25, 160
    s_add_u32 s48, s48, s49
    v_add_u32 v22, s48, v22
    v_cmp_le_u32 vcc, 60, v1
    v_mov_b32 v23, 0
    v_mov_b32 v24, 15360
    v_cndmask_b32 v24, v23, v24, vcc
    v_add_u32 v24, v22, v24
    s_and_b32 s49, s20, 1
    s_cmp_eq_u32 s49, 0
    s_cselect_b32 s49, 4294875136, 0
    v_mov_b32 v25, s49
    v_cndmask_b32 v25, v23, v25, vcc
    v_add_u32 v25, v22, v25
    v_add_u32 v6, 0, v22
    v_add_u32 v7, 6720, v24
    v_add_u32 v8, 28800, v22
    v_add_u32 v9, 35520, v24
    v_add_u32 v10, 57600, v22
    v_add_u32 v11, 69120, v24
    v_add_u32 v12, 91200, v22
    v_add_u32 v13, 97920, v25
    s_waitcnt lgkmcnt(0)
    s_mov_b32 s8, s32
    s_mov_b32 s9, s33
    s_mov_b32 s10, 2457600
    s_branch K_SETD
K_HSET:
    v_lshrrev_b32 v20, 3, v1
    v_and_b32 v21, 7, v1
    v_lshrrev_b32 v22, 1, v21
    v_lshrrev_b32 v23, 1, v20
    v_and_b32 v23, 3, v23
    v_xor_b32 v22, v22, v23
    v_and_b32 v21, 1, v21
    v_lshlrev_b32 v21, 4, v21
    v_lshl_add_u32 v21, v22, 5, v21
    v_lshrrev_b32 v22, 2, v20
    v_and_b32 v23, 3, v20
    v_lshl_add_u32 v22, v22, 3, v23
    v_mul_u32_u24 v22, 3456, v22
    s_lshl_b32 s48, s25, 9
    s_lshl_b32 s49, s20, 7
    s_add_u32 s48, s48, s49
    v_add3_u32 v22, v22, v21, s48
    v_add_u32 v6, 0, v22
    v_add_u32 v7, 54272, v22
    v_add_u32 v8, 11776, v22
    v_add_u32 v9, 66048, v22
    v_add_u32 v10, 110592, v22
    v_add_u32 v11, 164864, v22
    v_add_u32 v12, 122368, v22
    v_add_u32 v13, 176640, v22
    s_waitcnt lgkmcnt(0)
    s_mov_b32 s8, s36
    s_mov_b32 s9, s37
    s_mov_b32 s10, 2211840
K_SETD:
    s_mov_b32 s11, 0x20000
    s_mov_b32 s6, 2621440
    s_mov_b32 s7, 0x20000
    s_mov_b32 s12, s42
    s_mov_b32 s13, s43
    s_mov_b32 s14, 13762560
    s_mov_b32 s15, 0x20000
    s_mov_b32 s18, 1280
    s_mov_b32 s19, 0x20000
    s_mov_b32 s96, s40
    s_mov_b32 s97, s41
    s_mov_b32 s98, 256
    s_mov_b32 s99, 0x20000
    s_cmp_eq_u32 s23, 1
    s_cbranch_scc1 K_LOADH
    s_mov_b32 s40, s32
    s_mov_b32 s41, s33
    s_mov_b32 s42, 2457600
    s_mov_b32 s43, 0x20000
    s_mov_b32 s60, s36
    s_mov_b32 s61, s37
    s_mov_b32 s62, 2211840
    s_mov_b32 s63, 0x20000
    s_lshl_b32 s48, s2, 2
    s_add_u32 s48, s48, s20
    s_mov_b32 s49, 16384
    v_mul_u32_u24 v22, s49, v1
    v_lshrrev_b32 v22, 16, v22
    v_mul_u32_u24 v23, 4, v22
    v_sub_u32 v23, v1, v23
    s_lshl_b32 s49, s48, 1
    v_add_u32 v22, s49, v22
    v_mul_u32_u24 v22, 1280, v22
    v_add_u32 v23, 2, v23
    v_lshl_add_u32 v22, v23, 7, v22
    v_mov_b32 v23, 0x40000000
    v_cmp_gt_u32 vcc, 8, v1
    s_nop 1
    v_cndmask_b32 v24, v23, v22, vcc
    s_mul_i32 s49, s48, 8
    v_add_u32 v22, s49, v1
    v_lshlrev_b32 v22, 7, v22
    v_add_u32 v22, 491520, v22
    v_cmp_gt_u32 vcc, 8, v1
    s_nop 1
    v_cndmask_b32 v25, v23, v22, vcc
    s_mul_i32 s49, s48, 7
    v_add_u32 v22, s49, v1
    v_lshlrev_b32 v22, 7, v22
    v_add_u32 v22, 442368, v22
    v_cmp_gt_u32 vcc, 7, v1
    s_nop 1
    v_cndmask_b32 v26, v23, v22, vcc
    s_lshl_b32 s48, s2, 2
    s_add_u32 s48, s48, s20
    s_mov_b32 s49, 16384
    v_mul_u32_u24 v22, s49, v1
    v_lshrrev_b32 v22, 16, v22
    v_mul_u32_u24 v23, 4, v22
    v_sub_u32 v23, v1, v23
    s_lshl_b32 s49, s48, 1
    v_add_u32 v22, s49, v22
    v_mul_u32_u24 v22, 1280, v22
    v_add_u32 v23, 6, v23
    v_lshl_add_u32 v22, v23, 7, v22
    v_mov_b32 v23, 0x40000000
    v_cmp_gt_u32 vcc, 8, v1
    s_nop 1
    v_cndmask_b32 v56, v23, v22, vcc
    s_mul_i32 s49, s48, 8
    v_add_u32 v22, s49, v1
    v_lshlrev_b32 v22, 7, v22
    v_add_u32 v22, 1474560, v22
    v_cmp_gt_u32 vcc, 8, v1
    s_nop 1
    v_cndmask_b32 v57, v23, v22, vcc
    s_mul_i32 s49, s48, 7
    v_add_u32 v22, s49, v1
    v_lshlrev_b32 v22, 7, v22
    v_add_u32 v22, 1327104, v22
    v_cmp_gt_u32 vcc, 7, v1
    s_nop 1
    v_cndmask_b32 v58, v23, v22, vcc
    s_lshl_b32 s48, s20, 12
    s_add_u32 m0, s48, 0
    s_nop 0
    buffer_load_dwordx4 v2, s[4:7], s26 offen lds
    buffer_load_dwordx4 v3, s[4:7], s26 offen offset:1024 lds
    buffer_load_dwordx4 v4, s[4:7], s26 offen offset:2048 lds
    buffer_load_dwordx4 v5, s[4:7], s26 offen offset:3072 lds
    s_mul_i32 s48, s20, 7680
    s_add_u32 m0, s48, 16384
    s_mov_b32 exec_hi, 0x0fffffff
    buffer_load_dwordx4 v6, s[8:11], s27 offen lds
    buffer_load_dwordx4 v7, s[8:11], s27 offen offset:960 lds
    buffer_load_dwordx4 v8, s[8:11], s27 offen offset:1920 lds
    buffer_load_dwordx4 v9, s[8:11], s27 offen offset:2880 lds
    buffer_load_dwordx4 v10, s[8:11], s27 offen offset:3840 lds
    s_add_u32 m0, m0, 4800
    s_nop 0
    buffer_load_dwordx4 v11, s[8:11], s27 offen lds
    buffer_load_dwordx4 v12, s[8:11], s27 offen offset:960 lds
    buffer_load_dwordx4 v13, s[8:11], s27 offen offset:1920 lds
    s_mov_b32 exec_hi, -1
    s_add_u32 s26, s26, 128
    s_add_u32 s27, s27, 245760
    buffer_load_dword v30, v24, s[4:7], 0 offen
    buffer_load_dword v30, v25, s[40:43], 0 offen
    buffer_load_dword v30, v26, s[60:63], 0 offen
    s_lshl_b32 s48, s20, 12
    s_add_u32 m0, s48, 49152
    s_nop 0
    buffer_load_dwordx4 v2, s[4:7], s26 offen lds
    buffer_load_dwordx4 v3, s[4:7], s26 offen offset:1024 lds
    buffer_load_dwordx4 v4, s[4:7], s26 offen offset:2048 lds
    buffer_load_dwordx4 v5, s[4:7], s26 offen offset:3072 lds
    s_mul_i32 s48, s20, 7680
    s_add_u32 m0, s48, 65536
    s_mov_b32 exec_hi, 0x0fffffff
    buffer_load_dwordx4 v6, s[8:11], s27 offen lds
    buffer_load_dwordx4 v7, s[8:11], s27 offen offset:960 lds
    buffer_load_dwordx4 v8, s[8:11], s27 offen offset:1920 lds
    buffer_load_dwordx4 v9, s[8:11], s27 offen offset:2880 lds
    buffer_load_dwordx4 v10, s[8:11], s27 offen offset:3840 lds
    s_add_u32 m0, m0, 4800
    s_nop 0
    buffer_load_dwordx4 v11, s[8:11], s27 offen lds
    buffer_load_dwordx4 v12, s[8:11], s27 offen offset:960 lds
    buffer_load_dwordx4 v13, s[8:11], s27 offen offset:1920 lds
    s_mov_b32 exec_hi, -1
    s_add_u32 s26, s26, 128
    s_add_u32 s27, s27, 245760
    s_mul_i32 s49, s2, 6554
    s_lshr_b32 s49, s49, 16
    s_mul_i32 s51, s49, 10
    s_sub_u32 s51, s2, s51
    s_lshl_b32 s49, s49, 2
    s_add_u32 s49, s49, s20
    s_min_u32 s49, s49, 74
    s_mul_i32 s54, s49, 40960
    s_lshl_b32 s58, s51, 12
    s_add_u32 s54, s54, s58
    s_add_u32 s54, s54, 10485760
    v_lshrrev_b32 v20, 3, v1
    v_lshrrev_b32 v21, 5, v1
    v_mul_u32_u24 v21, 20, v21
    v_and_b32 v22, 3, v20
    v_add_u32 v21, v21, v22
    s_cmp_ge_u32 s49, 70
    s_cselect_b64 vcc, -1, 0
    v_cndmask_b32 v20, v20, v21, vcc
    v_mul_u32_u24 v20, 1280, v20
    v_and_b32 v21, 7, v1
    v_lshl_add_u32 v20, v21, 4, v20
    s_lshl_b32 s58, s51, 7
    v_add_u32 v16, s58, v20
    s_mov_b32 s47, 0x20000
    s_cmp_ge_u32 s49, 54
    s_cbranch_scc1 K_RPOA
    s_mov_b32 s44, s52
    s_mov_b32 s45, s53
    s_mov_b32 s46, 2211840
    s_mul_i32 s55, s49, 40960
    s_mov_b32 s56, 10240
    s_mov_b32 s57, 0
    s_branch K_RPDA
K_RPOA:
    s_mov_b32 s44, s34
    s_mov_b32 s45, s35
    s_mov_b32 s46, 819200
    s_cmp_ge_u32 s49, 70
    s_cbranch_scc1 K_RPXA
    s_sub_u32 s58, s49, 54
    s_mul_i32 s55, s58, 51200
    s_mov_b32 s56, 10240
    s_mov_b32 s57, 5120
    s_branch K_RPDA
K_RPXA:
    s_sub_u32 s58, s49, 70
    s_mul_i32 s55, s58, 204800
    s_add_u32 s55, s55, 20480
    s_mov_b32 s56, 51200
    s_mov_b32 s57, 0
K_RPDA:
    s_cmp_ge_u32 s49, 74
    s_cselect_b32 s55, 0x40000000, s55
    s_cselect_b32 s54, 0x40000000, s54
    v_lshrrev_b32 v20, 2, v1
    v_lshlrev_b32 v20, 7, v20
    v_and_b32 v21, 3, v1
    v_lshl_add_u32 v20, v21, 3, v20
    s_lshl_b32 s48, s20, 12
    s_add_u32 s48, s48, 147456
    v_add_u32 v17, s48, v20
    v_lshlrev_b32 v18, 4, v1
    s_waitcnt vmcnt(12)
    s_barrier
    s_lshl_b32 s48, s20, 12
    s_add_u32 m0, s48, 98304
    s_nop 0
    buffer_load_dwordx4 v2, s[4:7], s26 offen lds
    buffer_load_dwordx4 v3, s[4:7], s26 offen offset:1024 lds
    buffer_load_dwordx4 v4, s[4:7], s26 offen offset:2048 lds
    buffer_load_dwordx4 v5, s[4:7], s26 offen offset:3072 lds
    s_mul_i32 s48, s20, 7680
    s_add_u32 m0, s48, 114688
    s_mov_b32 exec_hi, 0x0fffffff
    buffer_load_dwordx4 v6, s[8:11], s27 offen lds
    buffer_load_dwordx4 v7, s[8:11], s27 offen offset:960 lds
    buffer_load_dwordx4 v8, s[8:11], s27 offen offset:1920 lds
    buffer_load_dwordx4 v9, s[8:11], s27 offen offset:2880 lds
    buffer_load_dwordx4 v10, s[8:11], s27 offen offset:3840 lds
    s_add_u32 m0, m0, 4800
    s_nop 0
    buffer_load_dwordx4 v11, s[8:11], s27 offen lds
    buffer_load_dwordx4 v12, s[8:11], s27 offen offset:960 lds
    buffer_load_dwordx4 v13, s[8:11], s27 offen offset:1920 lds
    s_mov_b32 exec_hi, -1
    s_add_u32 s26, s26, 128
    s_add_u32 s27, s27, 245760
    buffer_load_dword v30, v56, s[4:7], 0 offen
    buffer_load_dword v30, v57, s[40:43], 0 offen
    buffer_load_dword v30, v58, s[60:63], 0 offen
    s_waitcnt vmcnt(15)
    s_barrier
    s_lshl_b32 s48, s20, 12
    s_add_u32 m0, s48, 0
    s_nop 0
    buffer_load_dwordx4 v2, s[4:7], s26 offen lds
    buffer_load_dwordx4 v3, s[4:7], s26 offen offset:1024 lds
    buffer_load_dwordx4 v4, s[4:7], s26 offen offset:2048 lds
    buffer_load_dwordx4 v5, s[4:7], s26 offen offset:3072 lds
    s_mul_i32 s48, s20, 7680
    s_add_u32 m0, s48, 16384
    s_mov_b32 exec_hi, 0x0fffffff
    buffer_load_dwordx4 v6, s[8:11], s27 offen lds
    buffer_load_dwordx4 v7, s[8:11], s27 offen offset:960 lds
    buffer_load_dwordx4 v8, s[8:11], s27 offen offset:1920 lds
    buffer_load_dwordx4 v9, s[8:11], s27 offen offset:2880 lds
    buffer_load_dwordx4 v10, s[8:11], s27 offen offset:3840 lds
    s_add_u32 m0, m0, 4800
    s_nop 0
    buffer_load_dwordx4 v11, s[8:11], s27 offen lds
    buffer_load_dwordx4 v12, s[8:11], s27 offen offset:960 lds
    buffer_load_dwordx4 v13, s[8:11], s27 offen offset:1920 lds
    s_mov_b32 exec_hi, -1
    s_add_u32 s26, s26, 128
    s_add_u32 s27, s27, 245760
    s_waitcnt vmcnt(15)
    s_barrier
    s_lshl_b32 s48, s20, 12
    s_add_u32 m0, s48, 49152
    s_nop 0
    buffer_load_dwordx4 v2, s[4:7], s26 offen lds
    buffer_load_dwordx4 v3, s[4:7], s26 offen offset:1024 lds
    buffer_load_dwordx4 v4, s[4:7], s26 offen offset:2048 lds
    buffer_load_dwordx4 v5, s[4:7], s26 offen offset:3072 lds
    s_mul_i32 s48, s20, 7680
    s_add_u32 m0, s48, 65536
    s_mov_b32 exec_hi, 0x0fffffff
    buffer_load_dwordx4 v6, s[8:11], s27 offen lds
    buffer_load_dwordx4 v7, s[8:11], s27 offen offset:960 lds
    buffer_load_dwordx4 v8, s[8:11], s27 offen offset:1920 lds
    buffer_load_dwordx4 v9, s[8:11], s27 offen offset:2880 lds
    buffer_load_dwordx4 v10, s[8:11], s27 offen offset:3840 lds
    s_add_u32 m0, m0, 4800
    s_nop 0
    buffer_load_dwordx4 v11, s[8:11], s27 offen lds
    buffer_load_dwordx4 v12, s[8:11], s27 offen offset:960 lds
    buffer_load_dwordx4 v13, s[8:11], s27 offen offset:1920 lds
    s_mov_b32 exec_hi, -1
    s_add_u32 s26, s26, 128
    s_add_u32 s27, s27, 245760
    s_lshl_b32 s58, s20, 12
    s_add_u32 m0, s58, 147456
    s_nop 0
    buffer_load_dwordx4 v16, s[44:47], s55 offen lds
    s_add_u32 s55, s55, s56
    s_add_u32 m0, m0, 1024
    s_nop 0
    buffer_load_dwordx4 v16, s[44:47], s55 offen lds
    s_add_u32 s55, s55, s56
    s_add_u32 s55, s55, s57
    s_add_u32 m0, m0, 1024
    s_nop 0
    buffer_load_dwordx4 v16, s[44:47], s55 offen lds
    s_add_u32 s55, s55, s56
    s_add_u32 m0, m0, 1024
    s_nop 0
    buffer_load_dwordx4 v16, s[44:47], s55 offen lds
    s_cmp_eq_u32 s20, 0
    s_cselect_b32 s49, 0, 0x40000000
    v_mov_b32 v22, s49
    s_mov_b64 exec, 1
    buffer_load_dword v23, v22, s[96:99], 0 offen
    s_mov_b64 exec, -1
    s_waitcnt vmcnt(17)
    s_barrier
    s_lshl_b32 s48, s20, 12
    s_add_u32 m0, s48, 98304
    s_nop 0
    buffer_load_dwordx4 v2, s[4:7], s26 offen lds
    buffer_load_dwordx4 v3, s[4:7], s26 offen offset:1024 lds
    buffer_load_dwordx4 v4, s[4:7], s26 offen offset:2048 lds
    buffer_load_dwordx4 v5, s[4:7], s26 offen offset:3072 lds
    s_mul_i32 s48, s20, 7680
    s_add_u32 m0, s48, 114688
    s_mov_b32 exec_hi, 0x0fffffff
    buffer_load_dwordx4 v6, s[8:11], s27 offen lds
    buffer_load_dwordx4 v7, s[8:11], s27 offen offset:960 lds
    buffer_load_dwordx4 v8, s[8:11], s27 offen offset:1920 lds
    buffer_load_dwordx4 v9, s[8:11], s27 offen offset:2880 lds
    buffer_load_dwordx4 v10, s[8:11], s27 offen offset:3840 lds
    s_add_u32 m0, m0, 4800
    s_nop 0
    buffer_load_dwordx4 v11, s[8:11], s27 offen lds
    buffer_load_dwordx4 v12, s[8:11], s27 offen offset:960 lds
    buffer_load_dwordx4 v13, s[8:11], s27 offen offset:1920 lds
    s_mov_b32 exec_hi, -1
    s_add_u32 s26, s26, 128
    s_add_u32 s27, s27, 245760
    s_waitcnt vmcnt(17)
    s_barrier
    s_lshl_b32 s48, s20, 12
    s_add_u32 m0, s48, 0
    s_nop 0
    buffer_load_dwordx4 v2, s[4:7], s26 offen lds
    buffer_load_dwordx4 v3, s[4:7], s26 offen offset:1024 lds
    buffer_load_dwordx4 v4, s[4:7], s26 offen offset:2048 lds
    buffer_load_dwordx4 v5, s[4:7], s26 offen offset:3072 lds
    s_mul_i32 s48, s20, 7680
    s_add_u32 m0, s48, 16384
    s_mov_b32 exec_hi, 0x0fffffff
    buffer_load_dwordx4 v6, s[8:11], s27 offen lds
    buffer_load_dwordx4 v7, s[8:11], s27 offen offset:960 lds
    buffer_load_dwordx4 v8, s[8:11], s27 offen offset:1920 lds
    buffer_load_dwordx4 v9, s[8:11], s27 offen offset:2880 lds
    buffer_load_dwordx4 v10, s[8:11], s27 offen offset:3840 lds
    s_add_u32 m0, m0, 4800
    s_nop 0
    buffer_load_dwordx4 v11, s[8:11], s27 offen lds
    buffer_load_dwordx4 v12, s[8:11], s27 offen offset:960 lds
    buffer_load_dwordx4 v13, s[8:11], s27 offen offset:1920 lds
    s_mov_b32 exec_hi, -1
    s_add_u32 s26, s26, 128
    s_add_u32 s27, s27, 245760
    s_waitcnt vmcnt(12)
    s_barrier
    ds_read_b64_tr_b16 v[32:33], v17 offset:0
    ds_read_b64_tr_b16 v[34:35], v17 offset:2048
    ds_read_b64_tr_b16 v[36:37], v17 offset:32
    ds_read_b64_tr_b16 v[38:39], v17 offset:2080
    ds_read_b64_tr_b16 v[40:41], v17 offset:64
    ds_read_b64_tr_b16 v[42:43], v17 offset:2112
    ds_read_b64_tr_b16 v[44:45], v17 offset:96
    ds_read_b64_tr_b16 v[46:47], v17 offset:2144
    s_lshl_b32 s48, s20, 12
    s_add_u32 m0, s48, 49152
    s_nop 0
    buffer_load_dwordx4 v2, s[4:7], s26 offen lds
    buffer_load_dwordx4 v3, s[4:7], s26 offen offset:1024 lds
    buffer_load_dwordx4 v4, s[4:7], s26 offen offset:2048 lds
    buffer_load_dwordx4 v5, s[4:7], s26 offen offset:3072 lds
    s_mul_i32 s48, s20, 7680
    s_add_u32 m0, s48, 65536
    s_mov_b32 exec_hi, 0x0fffffff
    buffer_load_dwordx4 v6, s[8:11], s27 offen lds
    buffer_load_dwordx4 v7, s[8:11], s27 offen offset:960 lds
    buffer_load_dwordx4 v8, s[8:11], s27 offen offset:1920 lds
    buffer_load_dwordx4 v9, s[8:11], s27 offen offset:2880 lds
    buffer_load_dwordx4 v10, s[8:11], s27 offen offset:3840 lds
    s_add_u32 m0, m0, 4800
    s_nop 0
    buffer_load_dwordx4 v11, s[8:11], s27 offen lds
    buffer_load_dwordx4 v12, s[8:11], s27 offen offset:960 lds
    buffer_load_dwordx4 v13, s[8:11], s27 offen offset:1920 lds
    s_mov_b32 exec_hi, -1
    s_add_u32 s26, s26, 128
    s_add_u32 s27, s27, 245760
    s_waitcnt lgkmcnt(0)
    buffer_store_dwordx4 v[32:35], v18, s[12:15], s54 offen offset:0 sc1
    buffer_store_dwordx4 v[36:39], v18, s[12:15], s54 offen offset:1024 sc1
    buffer_store_dwordx4 v[40:43], v18, s[12:15], s54 offen offset:2048 sc1
    buffer_store_dwordx4 v[44:47], v18, s[12:15], s54 offen offset:3072 sc1
    s_cmp_lg_u32 s20, 0
    s_cbranch_scc1 K_NOZ_1
    v_mov_b32 v22, 147456
    v_mov_b32 v48, 0
    v_mov_b32 v49, 0
    v_mov_b32 v50, 0
    v_mov_b32 v51, 0
    ds_write_b128 v22, v[48:51]
    ds_write_b128 v22, v[48:51] offset:16
    ds_write_b128 v22, v[48:51] offset:32
    ds_write_b128 v22, v[48:51] offset:48
    ds_write_b128 v22, v[48:51] offset:64
    s_waitcnt lgkmcnt(0)
K_NOZ_1:
    s_waitcnt vmcnt(16)
    s_barrier
    s_lshl_b32 s48, s20, 12
    s_add_u32 m0, s48, 98304
    s_nop 0
    buffer_load_dwordx4 v2, s[4:7], s26 offen lds
    buffer_load_dwordx4 v3, s[4:7], s26 offen offset:1024 lds
    buffer_load_dwordx4 v4, s[4:7], s26 offen offset:2048 lds
    buffer_load_dwordx4 v5, s[4:7], s26 offen offset:3072 lds
    s_mul_i32 s48, s20, 7680
    s_add_u32 m0, s48, 114688
    s_mov_b32 exec_hi, 0x0fffffff
    buffer_load_dwordx4 v6, s[8:11], s27 offen lds
    buffer_load_dwordx4 v7, s[8:11], s27 offen offset:960 lds
    buffer_load_dwordx4 v8, s[8:11], s27 offen offset:1920 lds
    buffer_load_dwordx4 v9, s[8:11], s27 offen offset:2880 lds
    buffer_load_dwordx4 v10, s[8:11], s27 offen offset:3840 lds
    s_add_u32 m0, m0, 4800
    s_nop 0
    buffer_load_dwordx4 v11, s[8:11], s27 offen lds
    buffer_load_dwordx4 v12, s[8:11], s27 offen offset:960 lds
    buffer_load_dwordx4 v13, s[8:11], s27 offen offset:1920 lds
    s_mov_b32 exec_hi, -1
    s_add_u32 s26, s26, 128
    s_add_u32 s27, s27, 245760
    s_waitcnt vmcnt(16)
    s_barrier
    s_lshl_b32 s48, s20, 12
    s_add_u32 m0, s48, 0
    s_nop 0
    buffer_load_dwordx4 v2, s[4:7], s26 offen lds
    buffer_load_dwordx4 v3, s[4:7], s26 offen offset:1024 lds
    buffer_load_dwordx4 v4, s[4:7], s26 offen offset:2048 lds
    buffer_load_dwordx4 v5, s[4:7], s26 offen offset:3072 lds
    s_mul_i32 s48, s20, 7680
    s_add_u32 m0, s48, 16384
    s_mov_b32 exec_hi, 0x0fffffff
    buffer_load_dwordx4 v6, s[8:11], s27 offen lds
    buffer_load_dwordx4 v7, s[8:11], s27 offen offset:960 lds
    buffer_load_dwordx4 v8, s[8:11], s27 offen offset:1920 lds
    buffer_load_dwordx4 v9, s[8:11], s27 offen offset:2880 lds
    buffer_load_dwordx4 v10, s[8:11], s27 offen offset:3840 lds
    s_add_u32 m0, m0, 4800
    s_nop 0
    buffer_load_dwordx4 v11, s[8:11], s27 offen lds
    buffer_load_dwordx4 v12, s[8:11], s27 offen offset:960 lds
    buffer_load_dwordx4 v13, s[8:11], s27 offen offset:1920 lds
    s_mov_b32 exec_hi, -1
    s_add_u32 s26, s26, 128
    s_add_u32 s27, s27, 245760
    s_waitcnt vmcnt(12)
    s_barrier
    s_cmp_lg_u32 s20, 0
    s_cbranch_scc1 K_S0DA
    v_readfirstlane_b32 s48, v23
    s_mov_b32 s49, 1
    s_nop 3
    s_cmp_ge_u32 s48, s49
    s_cbranch_scc1 K_C0OKA
    s_waitcnt vmcnt(0)
    v_mov_b32 v22, 0
    s_mov_b32 s50, 131072
K_POLLC0A_2:
    buffer_load_dword v23, v22, s[96:99], 0 offen sc1
    s_sub_u32 s50, s50, 1
    s_cmp_eq_u32 s50, 0
    s_cbranch_scc1 K_POLLDC0A_3
    s_waitcnt vmcnt(0)
    v_cmp_gt_u32 vcc, s49, v23
    s_nop 3
    s_and_b64 vcc, vcc, exec
    s_cbranch_scc1 K_POLLC0A_2
K_POLLDC0A_3:
    s_waitcnt vmcnt(0)
K_C0OKA:
    v_mov_b32 v22, 147472
    v_mov_b32 v23, 1
    ds_write_b32 v22, v23
    s_lshl_b32 s48, s2, 7
    s_add_u32 s48, s48, 13697024
    v_mov_b32 v20, s48
    v_mov_b32 v21, 1
    s_mov_b64 exec, 1
    buffer_store_dword v21, v20, s[12:15], 0 offen sc1
    s_mov_b64 exec, -1
    s_waitcnt vmcnt(1) lgkmcnt(0)
    s_branch K_B8A
K_S0DA:
    s_waitcnt vmcnt(0)
K_B8A:
    s_barrier
    v_mov_b32 v162, 0x40000000
    v_mov_b32 v192, 0x40000000
    s_branch K_LTAIL
K_LOADH:
    s_mov_b32 s40, s32
    s_mov_b32 s41, s33
    s_mov_b32 s42, 2457600
    s_mov_b32 s43, 0x20000
    s_mov_b32 s60, s36
    s_mov_b32 s61, s37
    s_mov_b32 s62, 2211840
    s_mov_b32 s63, 0x20000
    s_lshl_b32 s48, s2, 2
    s_add_u32 s48, s48, s20
    s_mov_b32 s49, 16384
    v_mul_u32_u24 v22, s49, v1
    v_lshrrev_b32 v22, 16, v22
    v_mul_u32_u24 v23, 4, v22
    v_sub_u32 v23, v1, v23
    s_lshl_b32 s49, s48, 1
    v_add_u32 v22, s49, v22
    v_mul_u32_u24 v22, 1280, v22
    v_add_u32 v23, 2, v23
    v_lshl_add_u32 v22, v23, 7, v22
    v_mov_b32 v23, 0x40000000
    v_cmp_gt_u32 vcc, 8, v1
    s_nop 1
    v_cndmask_b32 v24, v23, v22, vcc
    s_mul_i32 s49, s48, 8
    v_add_u32 v22, s49, v1
    v_lshlrev_b32 v22, 7, v22
    v_add_u32 v22, 491520, v22
    v_cmp_gt_u32 vcc, 8, v1
    s_nop 1
    v_cndmask_b32 v25, v23, v22, vcc
    s_mul_i32 s49, s48, 7
    v_add_u32 v22, s49, v1
    v_lshlrev_b32 v22, 7, v22
    v_add_u32 v22, 442368, v22
    v_cmp_gt_u32 vcc, 7, v1
    s_nop 1
    v_cndmask_b32 v26, v23, v22, vcc
    s_lshl_b32 s48, s2, 2
    s_add_u32 s48, s48, s20
    s_mov_b32 s49, 16384
    v_mul_u32_u24 v22, s49, v1
    v_lshrrev_b32 v22, 16, v22
    v_mul_u32_u24 v23, 4, v22
    v_sub_u32 v23, v1, v23
    s_lshl_b32 s49, s48, 1
    v_add_u32 v22, s49, v22
    v_mul_u32_u24 v22, 1280, v22
    v_add_u32 v23, 6, v23
    v_lshl_add_u32 v22, v23, 7, v22
    v_mov_b32 v23, 0x40000000
    v_cmp_gt_u32 vcc, 8, v1
    s_nop 1
    v_cndmask_b32 v56, v23, v22, vcc
    s_mul_i32 s49, s48, 8
    v_add_u32 v22, s49, v1
    v_lshlrev_b32 v22, 7, v22
    v_add_u32 v22, 1474560, v22
    v_cmp_gt_u32 vcc, 8, v1
    s_nop 1
    v_cndmask_b32 v57, v23, v22, vcc
    s_mul_i32 s49, s48, 7
    v_add_u32 v22, s49, v1
    v_lshlrev_b32 v22, 7, v22
    v_add_u32 v22, 1327104, v22
    v_cmp_gt_u32 vcc, 7, v1
    s_nop 1
    v_cndmask_b32 v58, v23, v22, vcc
    s_lshl_b32 s48, s20, 12
    s_add_u32 m0, s48, 0
    s_nop 0
    buffer_load_dwordx4 v2, s[4:7], s26 offen lds
    buffer_load_dwordx4 v3, s[4:7], s26 offen offset:1024 lds
    buffer_load_dwordx4 v4, s[4:7], s26 offen offset:2048 lds
    buffer_load_dwordx4 v5, s[4:7], s26 offen offset:3072 lds
    s_mul_i32 s48, s20, 8192
    s_add_u32 m0, s48, 16384
    s_nop 0
    buffer_load_dwordx4 v6, s[8:11], s27 offen lds
    buffer_load_dwordx4 v7, s[8:11], s27 offen offset:1024 lds
    buffer_load_dwordx4 v8, s[8:11], s27 offen offset:2048 lds
    buffer_load_dwordx4 v9, s[8:11], s27 offen offset:3072 lds
    s_add_u32 m0, m0, 4096
    s_nop 0
    buffer_load_dwordx4 v10, s[8:11], s27 offen lds
    buffer_load_dwordx4 v11, s[8:11], s27 offen offset:1024 lds
    buffer_load_dwordx4 v12, s[8:11], s27 offen offset:2048 lds
    buffer_load_dwordx4 v13, s[8:11], s27 offen offset:3072 lds
    s_add_u32 s26, s26, 128
    s_add_u32 s27, s27, 221184
    buffer_load_dword v30, v24, s[4:7], 0 offen
    buffer_load_dword v30, v25, s[40:43], 0 offen
    buffer_load_dword v30, v26, s[60:63], 0 offen
    s_lshl_b32 s48, s20, 12
    s_add_u32 m0, s48, 49152
    s_nop 0
    buffer_load_dwordx4 v2, s[4:7], s26 offen lds
    buffer_load_dwordx4 v3, s[4:7], s26 offen offset:1024 lds
    buffer_load_dwordx4 v4, s[4:7], s26 offen offset:2048 lds
    buffer_load_dwordx4 v5, s[4:7], s26 offen offset:3072 lds
    s_mul_i32 s48, s20, 8192
    s_add_u32 m0, s48, 65536
    s_nop 0
    buffer_load_dwordx4 v6, s[8:11], s27 offen lds
    buffer_load_dwordx4 v7, s[8:11], s27 offen offset:1024 lds
    buffer_load_dwordx4 v8, s[8:11], s27 offen offset:2048 lds
    buffer_load_dwordx4 v9, s[8:11], s27 offen offset:3072 lds
    s_add_u32 m0, m0, 4096
    s_nop 0
    buffer_load_dwordx4 v10, s[8:11], s27 offen lds
    buffer_load_dwordx4 v11, s[8:11], s27 offen offset:1024 lds
    buffer_load_dwordx4 v12, s[8:11], s27 offen offset:2048 lds
    buffer_load_dwordx4 v13, s[8:11], s27 offen offset:3072 lds
    s_add_u32 s26, s26, 128
    s_add_u32 s27, s27, 221184
    s_mul_i32 s49, s2, 6554
    s_lshr_b32 s49, s49, 16
    s_mul_i32 s51, s49, 10
    s_sub_u32 s51, s2, s51
    s_lshl_b32 s49, s49, 2
    s_add_u32 s49, s49, s20
    s_min_u32 s49, s49, 74
    s_mul_i32 s54, s49, 40960
    s_lshl_b32 s58, s51, 12
    s_add_u32 s54, s54, s58
    s_add_u32 s54, s54, 10485760
    v_lshrrev_b32 v20, 3, v1
    v_lshrrev_b32 v21, 5, v1
    v_mul_u32_u24 v21, 20, v21
    v_and_b32 v22, 3, v20
    v_add_u32 v21, v21, v22
    s_cmp_ge_u32 s49, 70
    s_cselect_b64 vcc, -1, 0
    v_cndmask_b32 v20, v20, v21, vcc
    v_mul_u32_u24 v20, 1280, v20
    v_and_b32 v21, 7, v1
    v_lshl_add_u32 v20, v21, 4, v20
    s_lshl_b32 s58, s51, 7
    v_add_u32 v16, s58, v20
    s_mov_b32 s47, 0x20000
    s_cmp_ge_u32 s49, 54
    s_cbranch_scc1 K_RPOH
    s_mov_b32 s44, s52
    s_mov_b32 s45, s53
    s_mov_b32 s46, 2211840
    s_mul_i32 s55, s49, 40960
    s_mov_b32 s56, 10240
    s_mov_b32 s57, 0
    s_branch K_RPDH
K_RPOH:
    s_mov_b32 s44, s34
    s_mov_b32 s45, s35
    s_mov_b32 s46, 819200
    s_cmp_ge_u32 s49, 70
    s_cbranch_scc1 K_RPXH
    s_sub_u32 s58, s49, 54
    s_mul_i32 s55, s58, 51200
    s_mov_b32 s56, 10240
    s_mov_b32 s57, 5120
    s_branch K_RPDH
K_RPXH:
    s_sub_u32 s58, s49, 70
    s_mul_i32 s55, s58, 204800
    s_add_u32 s55, s55, 20480
    s_mov_b32 s56, 51200
    s_mov_b32 s57, 0
K_RPDH:
    s_cmp_ge_u32 s49, 74
    s_cselect_b32 s55, 0x40000000, s55
    s_cselect_b32 s54, 0x40000000, s54
    v_lshrrev_b32 v20, 2, v1
    v_lshlrev_b32 v20, 7, v20
    v_and_b32 v21, 3, v1
    v_lshl_add_u32 v20, v21, 3, v20
    s_lshl_b32 s48, s20, 12
    s_add_u32 s48, s48, 147456
    v_add_u32 v17, s48, v20
    v_lshlrev_b32 v18, 4, v1
    s_waitcnt vmcnt(12)
    s_barrier
    s_lshl_b32 s48, s20, 12
    s_add_u32 m0, s48, 98304
    s_nop 0
    buffer_load_dwordx4 v2, s[4:7], s26 offen lds
    buffer_load_dwordx4 v3, s[4:7], s26 offen offset:1024 lds
    buffer_load_dwordx4 v4, s[4:7], s26 offen offset:2048 lds
    buffer_load_dwordx4 v5, s[4:7], s26 offen offset:3072 lds
    s_mul_i32 s48, s20, 8192
    s_add_u32 m0, s48, 114688
    s_nop 0
    buffer_load_dwordx4 v6, s[8:11], s27 offen lds
    buffer_load_dwordx4 v7, s[8:11], s27 offen offset:1024 lds
    buffer_load_dwordx4 v8, s[8:11], s27 offen offset:2048 lds
    buffer_load_dwordx4 v9, s[8:11], s27 offen offset:3072 lds
    s_add_u32 m0, m0, 4096
    s_nop 0
    buffer_load_dwordx4 v10, s[8:11], s27 offen lds
    buffer_load_dwordx4 v11, s[8:11], s27 offen offset:1024 lds
    buffer_load_dwordx4 v12, s[8:11], s27 offen offset:2048 lds
    buffer_load_dwordx4 v13, s[8:11], s27 offen offset:3072 lds
    s_add_u32 s26, s26, 128
    s_add_u32 s27, s27, 221184
    buffer_load_dword v30, v56, s[4:7], 0 offen
    buffer_load_dword v30, v57, s[40:43], 0 offen
    buffer_load_dword v30, v58, s[60:63], 0 offen
    s_waitcnt vmcnt(15)
    s_barrier
    s_lshl_b32 s48, s20, 12
    s_add_u32 m0, s48, 0
    s_nop 0
    buffer_load_dwordx4 v2, s[4:7], s26 offen lds
    buffer_load_dwordx4 v3, s[4:7], s26 offen offset:1024 lds
    buffer_load_dwordx4 v4, s[4:7], s26 offen offset:2048 lds
    buffer_load_dwordx4 v5, s[4:7], s26 offen offset:3072 lds
    s_mul_i32 s48, s20, 8192
    s_add_u32 m0, s48, 16384
    s_nop 0
    buffer_load_dwordx4 v6, s[8:11], s27 offen lds
    buffer_load_dwordx4 v7, s[8:11], s27 offen offset:1024 lds
    buffer_load_dwordx4 v8, s[8:11], s27 offen offset:2048 lds
    buffer_load_dwordx4 v9, s[8:11], s27 offen offset:3072 lds
    s_add_u32 m0, m0, 4096
    s_nop 0
    buffer_load_dwordx4 v10, s[8:11], s27 offen lds
    buffer_load_dwordx4 v11, s[8:11], s27 offen offset:1024 lds
    buffer_load_dwordx4 v12, s[8:11], s27 offen offset:2048 lds
    buffer_load_dwordx4 v13, s[8:11], s27 offen offset:3072 lds
    s_add_u32 s26, s26, 128
    s_add_u32 s27, s27, 221184
    s_waitcnt vmcnt(15)
    s_barrier
    s_lshl_b32 s48, s20, 12
    s_add_u32 m0, s48, 49152
    s_nop 0
    buffer_load_dwordx4 v2, s[4:7], s26 offen lds
    buffer_load_dwordx4 v3, s[4:7], s26 offen offset:1024 lds
    buffer_load_dwordx4 v4, s[4:7], s26 offen offset:2048 lds
    buffer_load_dwordx4 v5, s[4:7], s26 offen offset:3072 lds
    s_mul_i32 s48, s20, 8192
    s_add_u32 m0, s48, 65536
    s_nop 0
    buffer_load_dwordx4 v6, s[8:11], s27 offen lds
    buffer_load_dwordx4 v7, s[8:11], s27 offen offset:1024 lds
    buffer_load_dwordx4 v8, s[8:11], s27 offen offset:2048 lds
    buffer_load_dwordx4 v9, s[8:11], s27 offen offset:3072 lds
    s_add_u32 m0, m0, 4096
    s_nop 0
    buffer_load_dwordx4 v10, s[8:11], s27 offen lds
    buffer_load_dwordx4 v11, s[8:11], s27 offen offset:1024 lds
    buffer_load_dwordx4 v12, s[8:11], s27 offen offset:2048 lds
    buffer_load_dwordx4 v13, s[8:11], s27 offen offset:3072 lds
    s_add_u32 s26, s26, 128
    s_add_u32 s27, s27, 221184
    s_lshl_b32 s58, s20, 12
    s_add_u32 m0, s58, 147456
    s_nop 0
    buffer_load_dwordx4 v16, s[44:47], s55 offen lds
    s_add_u32 s55, s55, s56
    s_add_u32 m0, m0, 1024
    s_nop 0
    buffer_load_dwordx4 v16, s[44:47], s55 offen lds
    s_add_u32 s55, s55, s56
    s_add_u32 s55, s55, s57
    s_add_u32 m0, m0, 1024
    s_nop 0
    buffer_load_dwordx4 v16, s[44:47], s55 offen lds
    s_add_u32 s55, s55, s56
    s_add_u32 m0, m0, 1024
    s_nop 0
    buffer_load_dwordx4 v16, s[44:47], s55 offen lds
    s_cmp_eq_u32 s20, 0
    s_cselect_b32 s49, 0, 0x40000000
    v_mov_b32 v22, s49
    s_mov_b64 exec, 1
    buffer_load_dword v23, v22, s[96:99], 0 offen
    s_mov_b64 exec, -1
    s_waitcnt vmcnt(17)
    s_barrier
    s_lshl_b32 s48, s20, 12
    s_add_u32 m0, s48, 98304
    s_nop 0
    buffer_load_dwordx4 v2, s[4:7], s26 offen lds
    buffer_load_dwordx4 v3, s[4:7], s26 offen offset:1024 lds
    buffer_load_dwordx4 v4, s[4:7], s26 offen offset:2048 lds
    buffer_load_dwordx4 v5, s[4:7], s26 offen offset:3072 lds
    s_mul_i32 s48, s20, 8192
    s_add_u32 m0, s48, 114688
    s_nop 0
    buffer_load_dwordx4 v6, s[8:11], s27 offen lds
    buffer_load_dwordx4 v7, s[8:11], s27 offen offset:1024 lds
    buffer_load_dwordx4 v8, s[8:11], s27 offen offset:2048 lds
    buffer_load_dwordx4 v9, s[8:11], s27 offen offset:3072 lds
    s_add_u32 m0, m0, 4096
    s_nop 0
    buffer_load_dwordx4 v10, s[8:11], s27 offen lds
    buffer_load_dwordx4 v11, s[8:11], s27 offen offset:1024 lds
    buffer_load_dwordx4 v12, s[8:11], s27 offen offset:2048 lds
    buffer_load_dwordx4 v13, s[8:11], s27 offen offset:3072 lds
    s_add_u32 s26, s26, 128
    s_add_u32 s27, s27, 221184
    s_waitcnt vmcnt(17)
    s_barrier
    s_lshl_b32 s48, s20, 12
    s_add_u32 m0, s48, 0
    s_nop 0
    buffer_load_dwordx4 v2, s[4:7], s26 offen lds
    buffer_load_dwordx4 v3, s[4:7], s26 offen offset:1024 lds
    buffer_load_dwordx4 v4, s[4:7], s26 offen offset:2048 lds
    buffer_load_dwordx4 v5, s[4:7], s26 offen offset:3072 lds
    s_mul_i32 s48, s20, 8192
    s_add_u32 m0, s48, 16384
    s_nop 0
    buffer_load_dwordx4 v6, s[8:11], s27 offen lds
    buffer_load_dwordx4 v7, s[8:11], s27 offen offset:1024 lds
    buffer_load_dwordx4 v8, s[8:11], s27 offen offset:2048 lds
    buffer_load_dwordx4 v9, s[8:11], s27 offen offset:3072 lds
    s_add_u32 m0, m0, 4096
    s_nop 0
    buffer_load_dwordx4 v10, s[8:11], s27 offen lds
    buffer_load_dwordx4 v11, s[8:11], s27 offen offset:1024 lds
    buffer_load_dwordx4 v12, s[8:11], s27 offen offset:2048 lds
    buffer_load_dwordx4 v13, s[8:11], s27 offen offset:3072 lds
    s_add_u32 s26, s26, 128
    s_add_u32 s27, s27, 221184
    s_waitcnt vmcnt(12)
    s_barrier
    ds_read_b64_tr_b16 v[32:33], v17 offset:0
    ds_read_b64_tr_b16 v[34:35], v17 offset:2048
    ds_read_b64_tr_b16 v[36:37], v17 offset:32
    ds_read_b64_tr_b16 v[38:39], v17 offset:2080
    ds_read_b64_tr_b16 v[40:41], v17 offset:64
    ds_read_b64_tr_b16 v[42:43], v17 offset:2112
    ds_read_b64_tr_b16 v[44:45], v17 offset:96
    ds_read_b64_tr_b16 v[46:47], v17 offset:2144
    s_lshl_b32 s48, s20, 12
    s_add_u32 m0, s48, 49152
    s_nop 0
    buffer_load_dwordx4 v2, s[4:7], s26 offen lds
    buffer_load_dwordx4 v3, s[4:7], s26 offen offset:1024 lds
    buffer_load_dwordx4 v4, s[4:7], s26 offen offset:2048 lds
    buffer_load_dwordx4 v5, s[4:7], s26 offen offset:3072 lds
    s_mul_i32 s48, s20, 8192
    s_add_u32 m0, s48, 65536
    s_nop 0
    buffer_load_dwordx4 v6, s[8:11], s27 offen lds
    buffer_load_dwordx4 v7, s[8:11], s27 offen offset:1024 lds
    buffer_load_dwordx4 v8, s[8:11], s27 offen offset:2048 lds
    buffer_load_dwordx4 v9, s[8:11], s27 offen offset:3072 lds
    s_add_u32 m0, m0, 4096
    s_nop 0
    buffer_load_dwordx4 v10, s[8:11], s27 offen lds
    buffer_load_dwordx4 v11, s[8:11], s27 offen offset:1024 lds
    buffer_load_dwordx4 v12, s[8:11], s27 offen offset:2048 lds
    buffer_load_dwordx4 v13, s[8:11], s27 offen offset:3072 lds
    s_add_u32 s26, s26, 128
    s_add_u32 s27, s27, 221184
    s_waitcnt lgkmcnt(0)
    buffer_store_dwordx4 v[32:35], v18, s[12:15], s54 offen offset:0 sc1
    buffer_store_dwordx4 v[36:39], v18, s[12:15], s54 offen offset:1024 sc1
    buffer_store_dwordx4 v[40:43], v18, s[12:15], s54 offen offset:2048 sc1
    buffer_store_dwordx4 v[44:47], v18, s[12:15], s54 offen offset:3072 sc1
    s_cmp_lg_u32 s20, 0
    s_cbranch_scc1 K_NOZ_4
    v_mov_b32 v22, 147456
    v_mov_b32 v48, 0
    v_mov_b32 v49, 0
    v_mov_b32 v50, 0
    v_mov_b32 v51, 0
    ds_write_b128 v22, v[48:51]
    ds_write_b128 v22, v[48:51] offset:16
    ds_write_b128 v22, v[48:51] offset:32
    ds_write_b128 v22, v[48:51] offset:48
    ds_write_b128 v22, v[48:51] offset:64
    s_waitcnt lgkmcnt(0)
K_NOZ_4:
    s_waitcnt vmcnt(16)
    s_barrier
    s_lshl_b32 s48, s20, 12
    s_add_u32 m0, s48, 98304
    s_nop 0
    buffer_load_dwordx4 v2, s[4:7], s26 offen lds
    buffer_load_dwordx4 v3, s[4:7], s26 offen offset:1024 lds
    buffer_load_dwordx4 v4, s[4:7], s26 offen offset:2048 lds
    buffer_load_dwordx4 v5, s[4:7], s26 offen offset:3072 lds
    s_mul_i32 s48, s20, 8192
    s_add_u32 m0, s48, 114688
    s_nop 0
    buffer_load_dwordx4 v6, s[8:11], s27 offen lds
    buffer_load_dwordx4 v7, s[8:11], s27 offen offset:1024 lds
    buffer_load_dwordx4 v8, s[8:11], s27 offen offset:2048 lds
    buffer_load_dwordx4 v9, s[8:11], s27 offen offset:3072 lds
    s_add_u32 m0, m0, 4096
    s_nop 0
    buffer_load_dwordx4 v10, s[8:11], s27 offen lds
    buffer_load_dwordx4 v11, s[8:11], s27 offen offset:1024 lds
    buffer_load_dwordx4 v12, s[8:11], s27 offen offset:2048 lds
    buffer_load_dwordx4 v13, s[8:11], s27 offen offset:3072 lds
    s_add_u32 s26, s26, 128
    s_add_u32 s27, s27, 221184
    s_waitcnt vmcnt(16)
    s_barrier
    s_lshl_b32 s48, s20, 12
    s_add_u32 m0, s48, 0
    s_nop 0
    buffer_load_dwordx4 v2, s[4:7], s26 offen lds
    buffer_load_dwordx4 v3, s[4:7], s26 offen offset:1024 lds
    buffer_load_dwordx4 v4, s[4:7], s26 offen offset:2048 lds
    buffer_load_dwordx4 v5, s[4:7], s26 offen offset:3072 lds
    s_mul_i32 s48, s20, 8192
    s_add_u32 m0, s48, 16384
    s_nop 0
    buffer_load_dwordx4 v6, s[8:11], s27 offen lds
    buffer_load_dwordx4 v7, s[8:11], s27 offen offset:1024 lds
    buffer_load_dwordx4 v8, s[8:11], s27 offen offset:2048 lds
    buffer_load_dwordx4 v9, s[8:11], s27 offen offset:3072 lds
    s_add_u32 m0, m0, 4096
    s_nop 0
    buffer_load_dwordx4 v10, s[8:11], s27 offen lds
    buffer_load_dwordx4 v11, s[8:11], s27 offen offset:1024 lds
    buffer_load_dwordx4 v12, s[8:11], s27 offen offset:2048 lds
    buffer_load_dwordx4 v13, s[8:11], s27 offen offset:3072 lds
    s_add_u32 s26, s26, 128
    s_add_u32 s27, s27, 221184
    s_lshr_b32 s48, s2, 3
    s_sub_u32 s48, s48, 18
    s_lshl_b32 s48, s48, 3
    s_and_b32 s49, s2, 7
    s_add_u32 s21, s48, s49
    s_mov_b64 s[56:57], -1
    v_lshrrev_b32 v160, 4, v15
    s_lshl_b32 s58, s21, 4
    v_add_u32 v160, s58, v160
    v_lshlrev_b32 v162, 3, v160
    v_add_u32 v162, 13631488, v162
    v_mul_u32_u24 v160, 1280, v160
    v_and_b32 v161, 15, v15
    v_cmp_eq_u32 vcc, 0, v161
    v_mul_u32_u24 v161, 80, v161
    v_add_u32 v160, v160, v161
    s_nop 1
    s_and_b64 vcc, vcc, s[56:57]
    v_mov_b32 v163, 0x40000000
    v_cndmask_b32 v162, v163, v162, vcc
    v_cndmask_b32_e64 v160, v163, v160, s[56:57]
    buffer_load_dwordx4 v[164:167], v160, s[4:7], 0 offen offset:0
    buffer_load_dwordx4 v[168:171], v160, s[4:7], 0 offen offset:16
    buffer_load_dwordx4 v[172:175], v160, s[4:7], 0 offen offset:32
    buffer_load_dwordx4 v[176:179], v160, s[4:7], 0 offen offset:48
    buffer_load_dwordx4 v[180:183], v160, s[4:7], 0 offen offset:64
    buffer_load_dwordx4 v[220:223], v161, s[16:19], 0 offen offset:0
    buffer_load_dwordx4 v[224:227], v161, s[16:19], 0 offen offset:16
    buffer_load_dwordx4 v[228:231], v161, s[16:19], 0 offen offset:32
    buffer_load_dwordx4 v[232:235], v161, s[16:19], 0 offen offset:48
    buffer_load_dwordx4 v[236:239], v161, s[16:19], 0 offen offset:64
    s_cmp_lt_u32 s21, 16
    s_cselect_b64 s[56:57], -1, 0
    s_add_u32 s21, s21, 112
    v_lshrrev_b32 v190, 4, v15
    s_lshl_b32 s58, s21, 4
    v_add_u32 v190, s58, v190
    v_lshlrev_b32 v192, 3, v190
    v_add_u32 v192, 13631488, v192
    v_mul_u32_u24 v190, 1280, v190
    v_and_b32 v191, 15, v15
    v_cmp_eq_u32 vcc, 0, v191
    v_mul_u32_u24 v191, 80, v191
    v_add_u32 v190, v190, v191
    s_nop 1
    s_and_b64 vcc, vcc, s[56:57]
    v_mov_b32 v193, 0x40000000
    v_cndmask_b32 v192, v193, v192, vcc
    v_cndmask_b32_e64 v190, v193, v190, s[56:57]
    buffer_load_dwordx4 v[194:197], v190, s[4:7], 0 offen offset:0
    buffer_load_dwordx4 v[198:201], v190, s[4:7], 0 offen offset:16
    buffer_load_dwordx4 v[202:205], v190, s[4:7], 0 offen offset:32
    buffer_load_dwordx4 v[206:209], v190, s[4:7], 0 offen offset:48
    buffer_load_dwordx4 v[210:213], v190, s[4:7], 0 offen offset:64
    s_waitcnt vmcnt(27)
    s_barrier
    s_cmp_lg_u32 s20, 0
    s_cbranch_scc1 K_S0DH
    v_readfirstlane_b32 s48, v23
    s_mov_b32 s49, 1
    s_nop 3
    s_cmp_ge_u32 s48, s49
    s_cbranch_scc1 K_C0OKH
    s_waitcnt vmcnt(0)
    v_mov_b32 v22, 0
    s_mov_b32 s50, 131072
K_POLLC0H_5:
    buffer_load_dword v23, v22, s[96:99], 0 offen sc1
    s_sub_u32 s50, s50, 1
    s_cmp_eq_u32 s50, 0
    s_cbranch_scc1 K_POLLDC0H_6
    s_waitcnt vmcnt(0)
    v_cmp_gt_u32 vcc, s49, v23
    s_nop 3
    s_and_b64 vcc, vcc, exec
    s_cbranch_scc1 K_POLLC0H_5
K_POLLDC0H_6:
    s_waitcnt vmcnt(0)
K_C0OKH:
    v_mov_b32 v22, 147472
    v_mov_b32 v23, 1
    ds_write_b32 v22, v23
    s_lshl_b32 s48, s2, 7
    s_add_u32 s48, s48, 13697024
    v_mov_b32 v20, s48
    v_mov_b32 v21, 1
    s_mov_b64 exec, 1
    buffer_store_dword v21, v20, s[12:15], 0 offen sc1
    s_mov_b64 exec, -1
    s_waitcnt vmcnt(16) lgkmcnt(0)
    s_branch K_B8H
K_S0DH:
    s_waitcnt vmcnt(15)
K_B8H:
    s_barrier
    s_branch K_LTAIL
K_LTAIL:
    s_and_b32 s48, s2, 7
    s_lshr_b32 s49, s2, 3
    s_lshr_b32 s21, s48, 1
    s_lshl_b32 s21, s21, 3
    s_and_b32 s51, s49, 7
    s_add_u32 s21, s21, s51
    s_and_b32 s22, s48, 1
    s_lshl_b32 s22, s22, 2
    s_lshr_b32 s51, s49, 3
    s_add_u32 s22, s22, s51
    s_cmp_lg_u32 s20, 0
    s_cbranch_scc1 K_LWAIT
    s_mul_i32 s48, s22, 5
    s_lshr_b32 s48, s48, 2
    v_cmp_le_u32 vcc, 19, v1
    v_mov_b32 v20, s48
    s_nop 0
    v_addc_co_u32 v20, vcc, 0, v20, vcc
    v_subrev_u32 v21, 19, v1
    v_min_u32 v21, v1, v21
    v_mul_u32_u24 v21, 10, v21
    v_add_u32 v20, v20, v21
    v_lshlrev_b32 v20, 7, v20
    v_add_u32 v20, 13697024, v20
    s_mov_b32 s46, 0xffffffff
    s_mov_b32 s47, 0x3f
    v_mov_b32 v21, 0x40000000
    v_cndmask_b32_e64 v20, v21, v20, s[46:47]
    s_mov_b32 s49, 1
    s_mov_b32 s50, 131072
K_POLLF1_7:
    buffer_load_dword v23, v20, s[12:15], 0 offen sc1
    s_sub_u32 s50, s50, 1
    s_cmp_eq_u32 s50, 0
    s_cbranch_scc1 K_POLLDF1_8
    s_waitcnt vmcnt(0)
    v_cmp_ne_u32 vcc, s49, v23
    s_nop 3
    s_and_b64 vcc, vcc, s[46:47]
    s_cbranch_scc1 K_POLLF1_7
K_POLLDF1_8:
    s_waitcnt vmcnt(0)
    v_mov_b32 v20, 147468
    v_mov_b32 v21, 1
    ds_write_b32 v20, v21
    s_waitcnt lgkmcnt(0)
    s_branch K_LGO
K_LWAIT:
    v_mov_b32 v20, 147468
    s_mov_b32 s50, 2097152
K_SPINWF_9:
    ds_read_b32 v21, v20
    s_sub_u32 s50, s50, 1
    s_cmp_eq_u32 s50, 0
    s_cbranch_scc1 K_SPINDWF_10
    s_waitcnt lgkmcnt(0)
    v_cmp_ne_u32 vcc, 1, v21
    s_nop 3
    s_cbranch_vccnz K_SPINWF_9
K_SPINDWF_10:
    s_waitcnt lgkmcnt(0)
K_LGO:
    v_lshlrev_b32 v3, 4, v1
    v_add_u32 v4, 4096, v3
    s_mul_i32 s28, s20, 35840
    s_mul_i32 s55, s20, 737280
    s_mul_i32 s49, s22, 5120
    s_add_u32 s55, s55, s49
    s_add_u32 s55, s55, 10485760
    v_add_u32 v2, s28, v3
    s_lshl_b32 s48, s20, 2
    s_add_u32 s48, s48, 147520
    v_mov_b32 v7, s48
    buffer_load_dwordx4 v[16:19], v3, s[12:15], s55 offen sc1
    buffer_load_dwordx4 v[20:23], v3, s[12:15], s55 offen offset:1024 sc1
    buffer_load_dwordx4 v[24:27], v3, s[12:15], s55 offen offset:2048 sc1
    buffer_load_dwordx4 v[28:31], v3, s[12:15], s55 offen offset:3072 sc1
    buffer_load_dwordx4 v[32:35], v4, s[12:15], s55 offen sc1
    s_add_u32 s55, s55, 40960
    buffer_load_dwordx4 v[36:39], v3, s[12:15], s55 offen sc1
    buffer_load_dwordx4 v[40:43], v3, s[12:15], s55 offen offset:1024 sc1
    buffer_load_dwordx4 v[44:47], v3, s[12:15], s55 offen offset:2048 sc1
    buffer_load_dwordx4 v[48:51], v3, s[12:15], s55 offen offset:3072 sc1
    buffer_load_dwordx4 v[52:55], v4, s[12:15], s55 offen sc1
    s_add_u32 s55, s55, 40960
    buffer_load_dwordx4 v[56:59], v3, s[12:15], s55 offen sc1
    buffer_load_dwordx4 v[60:63], v3, s[12:15], s55 offen offset:1024 sc1
    buffer_load_dwordx4 v[64:67], v3, s[12:15], s55 offen offset:2048 sc1
    buffer_load_dwordx4 v[68:71], v3, s[12:15], s55 offen offset:3072 sc1
    buffer_load_dwordx4 v[72:75], v4, s[12:15], s55 offen sc1
    s_add_u32 s55, s55, 40960
    buffer_load_dwordx4 v[76:79], v3, s[12:15], s55 offen sc1
    buffer_load_dwordx4 v[80:83], v3, s[12:15], s55 offen offset:1024 sc1
    buffer_load_dwordx4 v[84:87], v3, s[12:15], s55 offen offset:2048 sc1
    buffer_load_dwordx4 v[88:91], v3, s[12:15], s55 offen offset:3072 sc1
    buffer_load_dwordx4 v[92:95], v4, s[12:15], s55 offen sc1
    s_add_u32 s55, s55, 40960
    v_mov_b32 v5, 147480
    s_mov_b32 s50, 2097152
K_SPINFRX_11:
    ds_read_b32 v6, v5
    s_sub_u32 s50, s50, 1
    s_cmp_eq_u32 s50, 0
    s_cbranch_scc1 K_SPINDFRX_12
    s_waitcnt lgkmcnt(0)
    v_cmp_ne_u32 vcc, 4, v6
    s_nop 3
    s_cbranch_vccnz K_SPINFRX_11
K_SPINDFRX_12:
    s_waitcnt lgkmcnt(0)
    s_waitcnt vmcnt(15)
    ds_write_b128 v2, v[16:19] offset:0
    ds_write_b128 v2, v[20:23] offset:1024
    ds_write_b128 v2, v[24:27] offset:2048
    ds_write_b128 v2, v[28:31] offset:3072
    ds_write_b128 v2, v[32:35] offset:4096
    v_mov_b32 v8, 1
    ds_write_b32 v7, v8
    buffer_load_dwordx4 v[96:99], v3, s[12:15], s55 offen sc1
    buffer_load_dwordx4 v[100:103], v3, s[12:15], s55 offen offset:1024 sc1
    buffer_load_dwordx4 v[104:107], v3, s[12:15], s55 offen offset:2048 sc1
    buffer_load_dwordx4 v[108:111], v3, s[12:15], s55 offen offset:3072 sc1
    buffer_load_dwordx4 v[112:115], v4, s[12:15], s55 offen sc1
    s_add_u32 s55, s55, 40960
    s_waitcnt vmcnt(15)
    ds_write_b128 v2, v[36:39] offset:5120
    ds_write_b128 v2, v[40:43] offset:6144
    ds_write_b128 v2, v[44:47] offset:7168
    ds_write_b128 v2, v[48:51] offset:8192
    ds_write_b128 v2, v[52:55] offset:9216
    v_mov_b32 v8, 2
    ds_write_b32 v7, v8
    s_waitcnt lgkmcnt(0)
    buffer_load_dwordx4 v[16:19], v3, s[12:15], s55 offen sc1
    buffer_load_dwordx4 v[20:23], v3, s[12:15], s55 offen offset:1024 sc1
    buffer_load_dwordx4 v[24:27], v3, s[12:15], s55 offen offset:2048 sc1
    buffer_load_dwordx4 v[28:31], v3, s[12:15], s55 offen offset:3072 sc1
    buffer_load_dwordx4 v[32:35], v4, s[12:15], s55 offen sc1
    s_add_u32 s55, s55, 40960
    s_waitcnt vmcnt(15)
    ds_write_b128 v2, v[56:59] offset:10240
    ds_write_b128 v2, v[60:63] offset:11264
    ds_write_b128 v2, v[64:67] offset:12288
    ds_write_b128 v2, v[68:71] offset:13312
    ds_write_b128 v2, v[72:75] offset:14336
    v_mov_b32 v8, 3
    ds_write_b32 v7, v8
    s_waitcnt lgkmcnt(0)
    buffer_load_dwordx4 v[36:39], v3, s[12:15], s55 offen sc1
    buffer_load_dwordx4 v[40:43], v3, s[12:15], s55 offen offset:1024 sc1
    buffer_load_dwordx4 v[44:47], v3, s[12:15], s55 offen offset:2048 sc1
    buffer_load_dwordx4 v[48:51], v3, s[12:15], s55 offen offset:3072 sc1
    buffer_load_dwordx4 v[52:55], v4, s[12:15], s55 offen sc1
    s_add_u32 s55, s55, 40960
    s_waitcnt vmcnt(15)
    ds_write_b128 v2, v[76:79] offset:15360
    ds_write_b128 v2, v[80:83] offset:16384
    ds_write_b128 v2, v[84:87] offset:17408
    ds_write_b128 v2, v[88:91] offset:18432
    ds_write_b128 v2, v[92:95] offset:19456
    v_mov_b32 v8, 4
    ds_write_b32 v7, v8
    s_waitcnt vmcnt(10)
    ds_write_b128 v2, v[96:99] offset:20480
    ds_write_b128 v2, v[100:103] offset:21504
    ds_write_b128 v2, v[104:107] offset:22528
    ds_write_b128 v2, v[108:111] offset:23552
    ds_write_b128 v2, v[112:115] offset:24576
    v_mov_b32 v8, 5
    ds_write_b32 v7, v8
    s_waitcnt vmcnt(5)
    ds_write_b128 v2, v[16:19] offset:25600
    ds_write_b128 v2, v[20:23] offset:26624
    ds_write_b128 v2, v[24:27] offset:27648
    ds_write_b128 v2, v[28:31] offset:28672
    ds_write_b128 v2, v[32:35] offset:29696
    v_mov_b32 v8, 6
    ds_write_b32 v7, v8
    s_waitcnt vmcnt(0)
    ds_write_b128 v2, v[36:39] offset:30720
    ds_write_b128 v2, v[40:43] offset:31744
    ds_write_b128 v2, v[44:47] offset:32768
    ds_write_b128 v2, v[48:51] offset:33792
    ds_write_b128 v2, v[52:55] offset:34816
    v_mov_b32 v8, 7
    ds_write_b32 v7, v8
    s_waitcnt lgkmcnt(0)
    s_cmp_eq_u32 s23, 0
    s_cbranch_scc1 K_NOGATE2
    s_waitcnt vmcnt(0)
    v_and_b32 v100, 0xffff, v220
    v_and_b32 v120, 0xffff0000, v220
    v_and_b32 v101, 0xffff, v221
    v_and_b32 v121, 0xffff0000, v221
    v_and_b32 v102, 0xffff, v222
    v_and_b32 v122, 0xffff0000, v222
    v_and_b32 v103, 0xffff, v223
    v_and_b32 v123, 0xffff0000, v223
    v_and_b32 v104, 0xffff, v224
    v_and_b32 v124, 0xffff0000, v224
    v_and_b32 v105, 0xffff, v225
    v_and_b32 v125, 0xffff0000, v225
    v_and_b32 v106, 0xffff, v226
    v_and_b32 v126, 0xffff0000, v226
    v_and_b32 v107, 0xffff, v227
    v_and_b32 v127, 0xffff0000, v227
    v_and_b32 v108, 0xffff, v228
    v_and_b32 v128, 0xffff0000, v228
    v_and_b32 v109, 0xffff, v229
    v_and_b32 v129, 0xffff0000, v229
    v_and_b32 v110, 0xffff, v230
    v_and_b32 v130, 0xffff0000, v230
    v_and_b32 v111, 0xffff, v231
    v_and_b32 v131, 0xffff0000, v231
    v_and_b32 v112, 0xffff, v232
    v_and_b32 v132, 0xffff0000, v232
    v_and_b32 v113, 0xffff, v233
    v_and_b32 v133, 0xffff0000, v233
    v_and_b32 v114, 0xffff, v234
    v_and_b32 v134, 0xffff0000, v234
    v_and_b32 v115, 0xffff, v235
    v_and_b32 v135, 0xffff0000, v235
    v_and_b32 v116, 0xffff, v236
    v_and_b32 v136, 0xffff0000, v236
    v_and_b32 v117, 0xffff, v237
    v_and_b32 v137, 0xffff0000, v237
    v_and_b32 v118, 0xffff, v238
    v_and_b32 v138, 0xffff0000, v238
    v_and_b32 v119, 0xffff, v239
    v_and_b32 v139, 0xffff0000, v239
    v_mov_b32 v155, 0x3f803f80
    v_mov_b32 v160, 0
    v_dot2_f32_bf16 v140, v164, v100, 0
    v_dot2_f32_bf16 v141, v164, v120, 0
    v_dot2_f32_bf16 v142, v165, v101, 0
    v_dot2_f32_bf16 v143, v165, v121, 0
    v_dot2_f32_bf16 v144, v166, v102, 0
    v_dot2_f32_bf16 v145, v166, v122, 0
    v_dot2_f32_bf16 v146, v167, v103, 0
    v_dot2_f32_bf16 v147, v167, v123, 0
    v_cvt_pk_bf16_f32 v148, v140, v141
    v_cvt_pk_bf16_f32 v149, v142, v143
    v_cvt_pk_bf16_f32 v150, v144, v145
    v_cvt_pk_bf16_f32 v151, v146, v147
    v_dot2_f32_bf16 v160, v148, v155, v160
    v_dot2_f32_bf16 v160, v149, v155, v160
    v_dot2_f32_bf16 v160, v150, v155, v160
    v_dot2_f32_bf16 v160, v151, v155, v160
    v_dot2_f32_bf16 v140, v168, v104, 0
    v_dot2_f32_bf16 v141, v168, v124, 0
    v_dot2_f32_bf16 v142, v169, v105, 0
    v_dot2_f32_bf16 v143, v169, v125, 0
    v_dot2_f32_bf16 v144, v170, v106, 0
    v_dot2_f32_bf16 v145, v170, v126, 0
    v_dot2_f32_bf16 v146, v171, v107, 0
    v_dot2_f32_bf16 v147, v171, v127, 0
    v_cvt_pk_bf16_f32 v148, v140, v141
    v_cvt_pk_bf16_f32 v149, v142, v143
    v_cvt_pk_bf16_f32 v150, v144, v145
    v_cvt_pk_bf16_f32 v151, v146, v147
    v_dot2_f32_bf16 v160, v148, v155, v160
    v_dot2_f32_bf16 v160, v149, v155, v160
    v_dot2_f32_bf16 v160, v150, v155, v160
    v_dot2_f32_bf16 v160, v151, v155, v160
    v_dot2_f32_bf16 v140, v172, v108, 0
    v_dot2_f32_bf16 v141, v172, v128, 0
    v_dot2_f32_bf16 v142, v173, v109, 0
    v_dot2_f32_bf16 v143, v173, v129, 0
    v_dot2_f32_bf16 v144, v174, v110, 0
    v_dot2_f32_bf16 v145, v174, v130, 0
    v_dot2_f32_bf16 v146, v175, v111, 0
    v_dot2_f32_bf16 v147, v175, v131, 0
    v_cvt_pk_bf16_f32 v148, v140, v141
    v_cvt_pk_bf16_f32 v149, v142, v143
    v_cvt_pk_bf16_f32 v150, v144, v145
    v_cvt_pk_bf16_f32 v151, v146, v147
    v_dot2_f32_bf16 v160, v148, v155, v160
    v_dot2_f32_bf16 v160, v149, v155, v160
    v_dot2_f32_bf16 v160, v150, v155, v160
    v_dot2_f32_bf16 v160, v151, v155, v160
    v_dot2_f32_bf16 v140, v176, v112, 0
    v_dot2_f32_bf16 v141, v176, v132, 0
    v_dot2_f32_bf16 v142, v177, v113, 0
    v_dot2_f32_bf16 v143, v177, v133, 0
    v_dot2_f32_bf16 v144, v178, v114, 0
    v_dot2_f32_bf16 v145, v178, v134, 0
    v_dot2_f32_bf16 v146, v179, v115, 0
    v_dot2_f32_bf16 v147, v179, v135, 0
    v_cvt_pk_bf16_f32 v148, v140, v141
    v_cvt_pk_bf16_f32 v149, v142, v143
    v_cvt_pk_bf16_f32 v150, v144, v145
    v_cvt_pk_bf16_f32 v151, v146, v147
    v_dot2_f32_bf16 v160, v148, v155, v160
    v_dot2_f32_bf16 v160, v149, v155, v160
    v_dot2_f32_bf16 v160, v150, v155, v160
    v_dot2_f32_bf16 v160, v151, v155, v160
    v_dot2_f32_bf16 v140, v180, v116, 0
    v_dot2_f32_bf16 v141, v180, v136, 0
    v_dot2_f32_bf16 v142, v181, v117, 0
    v_dot2_f32_bf16 v143, v181, v137, 0
    v_dot2_f32_bf16 v144, v182, v118, 0
    v_dot2_f32_bf16 v145, v182, v138, 0
    v_dot2_f32_bf16 v146, v183, v119, 0
    v_dot2_f32_bf16 v147, v183, v139, 0
    v_cvt_pk_bf16_f32 v148, v140, v141
    v_cvt_pk_bf16_f32 v149, v142, v143
    v_cvt_pk_bf16_f32 v150, v144, v145
    v_cvt_pk_bf16_f32 v151, v146, v147
    v_dot2_f32_bf16 v160, v148, v155, v160
    v_dot2_f32_bf16 v160, v149, v155, v160
    v_dot2_f32_bf16 v160, v150, v155, v160
    v_dot2_f32_bf16 v160, v151, v155, v160
    s_nop 2
    v_add_f32_dpp v160, v160, v160 row_ror:8 row_mask:0xf bank_mask:0xf
    s_nop 2
    v_add_f32_dpp v160, v160, v160 row_ror:4 row_mask:0xf bank_mask:0xf
    s_nop 2
    v_add_f32_dpp v160, v160, v160 row_ror:2 row_mask:0xf bank_mask:0xf
    s_nop 2
    v_add_f32_dpp v160, v160, v160 row_ror:1 row_mask:0xf bank_mask:0xf
    v_cvt_pk_bf16_f32 v160, v160, v160
    v_lshlrev_b32 v160, 16, v160
    v_mul_f32 v160, 0xbfb8aa3b, v160
    v_exp_f32 v160, v160
    s_nop 0
    v_add_f32 v160, 1.0, v160
    v_rcp_f32 v160, v160
    s_nop 0
    v_cvt_pk_bf16_f32 v160, v160, v160
    v_lshlrev_b32 v184, 16, v160
    v_sub_f32 v160, 1.0, v184
    v_cvt_pk_bf16_f32 v160, v160, v160
    v_lshlrev_b32 v185, 16, v160
    buffer_store_dwordx2 v[184:185], v162, s[12:15], 0 offen sc1
    v_mov_b32 v190, 0
    v_dot2_f32_bf16 v140, v194, v100, 0
    v_dot2_f32_bf16 v141, v194, v120, 0
    v_dot2_f32_bf16 v142, v195, v101, 0
    v_dot2_f32_bf16 v143, v195, v121, 0
    v_dot2_f32_bf16 v144, v196, v102, 0
    v_dot2_f32_bf16 v145, v196, v122, 0
    v_dot2_f32_bf16 v146, v197, v103, 0
    v_dot2_f32_bf16 v147, v197, v123, 0
    v_cvt_pk_bf16_f32 v148, v140, v141
    v_cvt_pk_bf16_f32 v149, v142, v143
    v_cvt_pk_bf16_f32 v150, v144, v145
    v_cvt_pk_bf16_f32 v151, v146, v147
    v_dot2_f32_bf16 v190, v148, v155, v190
    v_dot2_f32_bf16 v190, v149, v155, v190
    v_dot2_f32_bf16 v190, v150, v155, v190
    v_dot2_f32_bf16 v190, v151, v155, v190
    v_dot2_f32_bf16 v140, v198, v104, 0
    v_dot2_f32_bf16 v141, v198, v124, 0
    v_dot2_f32_bf16 v142, v199, v105, 0
    v_dot2_f32_bf16 v143, v199, v125, 0
    v_dot2_f32_bf16 v144, v200, v106, 0
    v_dot2_f32_bf16 v145, v200, v126, 0
    v_dot2_f32_bf16 v146, v201, v107, 0
    v_dot2_f32_bf16 v147, v201, v127, 0
    v_cvt_pk_bf16_f32 v148, v140, v141
    v_cvt_pk_bf16_f32 v149, v142, v143
    v_cvt_pk_bf16_f32 v150, v144, v145
    v_cvt_pk_bf16_f32 v151, v146, v147
    v_dot2_f32_bf16 v190, v148, v155, v190
    v_dot2_f32_bf16 v190, v149, v155, v190
    v_dot2_f32_bf16 v190, v150, v155, v190
    v_dot2_f32_bf16 v190, v151, v155, v190
    v_dot2_f32_bf16 v140, v202, v108, 0
    v_dot2_f32_bf16 v141, v202, v128, 0
    v_dot2_f32_bf16 v142, v203, v109, 0
    v_dot2_f32_bf16 v143, v203, v129, 0
    v_dot2_f32_bf16 v144, v204, v110, 0
    v_dot2_f32_bf16 v145, v204, v130, 0
    v_dot2_f32_bf16 v146, v205, v111, 0
    v_dot2_f32_bf16 v147, v205, v131, 0
    v_cvt_pk_bf16_f32 v148, v140, v141
    v_cvt_pk_bf16_f32 v149, v142, v143
    v_cvt_pk_bf16_f32 v150, v144, v145
    v_cvt_pk_bf16_f32 v151, v146, v147
    v_dot2_f32_bf16 v190, v148, v155, v190
    v_dot2_f32_bf16 v190, v149, v155, v190
    v_dot2_f32_bf16 v190, v150, v155, v190
    v_dot2_f32_bf16 v190, v151, v155, v190
    v_dot2_f32_bf16 v140, v206, v112, 0
    v_dot2_f32_bf16 v141, v206, v132, 0
    v_dot2_f32_bf16 v142, v207, v113, 0
    v_dot2_f32_bf16 v143, v207, v133, 0
    v_dot2_f32_bf16 v144, v208, v114, 0
    v_dot2_f32_bf16 v145, v208, v134, 0
    v_dot2_f32_bf16 v146, v209, v115, 0
    v_dot2_f32_bf16 v147, v209, v135, 0
    v_cvt_pk_bf16_f32 v148, v140, v141
    v_cvt_pk_bf16_f32 v149, v142, v143
    v_cvt_pk_bf16_f32 v150, v144, v145
    v_cvt_pk_bf16_f32 v151, v146, v147
    v_dot2_f32_bf16 v190, v148, v155, v190
    v_dot2_f32_bf16 v190, v149, v155, v190
    v_dot2_f32_bf16 v190, v150, v155, v190
    v_dot2_f32_bf16 v190, v151, v155, v190
    v_dot2_f32_bf16 v140, v210, v116, 0
    v_dot2_f32_bf16 v141, v210, v136, 0
    v_dot2_f32_bf16 v142, v211, v117, 0
    v_dot2_f32_bf16 v143, v211, v137, 0
    v_dot2_f32_bf16 v144, v212, v118, 0
    v_dot2_f32_bf16 v145, v212, v138, 0
    v_dot2_f32_bf16 v146, v213, v119, 0
    v_dot2_f32_bf16 v147, v213, v139, 0
    v_cvt_pk_bf16_f32 v148, v140, v141
    v_cvt_pk_bf16_f32 v149, v142, v143
    v_cvt_pk_bf16_f32 v150, v144, v145
    v_cvt_pk_bf16_f32 v151, v146, v147
    v_dot2_f32_bf16 v190, v148, v155, v190
    v_dot2_f32_bf16 v190, v149, v155, v190
    v_dot2_f32_bf16 v190, v150, v155, v190
    v_dot2_f32_bf16 v190, v151, v155, v190
    s_nop 2
    v_add_f32_dpp v190, v190, v190 row_ror:8 row_mask:0xf bank_mask:0xf
    s_nop 2
    v_add_f32_dpp v190, v190, v190 row_ror:4 row_mask:0xf bank_mask:0xf
    s_nop 2
    v_add_f32_dpp v190, v190, v190 row_ror:2 row_mask:0xf bank_mask:0xf
    s_nop 2
    v_add_f32_dpp v190, v190, v190 row_ror:1 row_mask:0xf bank_mask:0xf
    v_cvt_pk_bf16_f32 v190, v190, v190
    v_lshlrev_b32 v190, 16, v190
    v_mul_f32 v190, 0xbfb8aa3b, v190
    v_exp_f32 v190, v190
    s_nop 0
    v_add_f32 v190, 1.0, v190
    v_rcp_f32 v190, v190
    s_nop 0
    v_cvt_pk_bf16_f32 v190, v190, v190
    v_lshlrev_b32 v214, 16, v190
    v_sub_f32 v190, 1.0, v214
    v_cvt_pk_bf16_f32 v190, v190, v190
    v_lshlrev_b32 v215, 16, v190
    buffer_store_dwordx2 v[214:215], v192, s[12:15], 0 offen sc1
    v_mov_b32 v20, 147476
    v_mov_b32 v21, 1
    s_waitcnt vmcnt(0)
    s_mov_b64 exec, 1
    ds_add_u32 v20, v21
    s_mov_b64 exec, -1
    s_cmp_lg_u32 s20, 3
    s_cbranch_scc1 K_SJD
    s_mov_b32 s50, 2097152
K_SPINL_13:
    ds_read_b32 v21, v20
    s_sub_u32 s50, s50, 1
    s_cmp_eq_u32 s50, 0
    s_cbranch_scc1 K_SPINDL_14
    s_waitcnt lgkmcnt(0)
    v_cmp_ne_u32 vcc, 4, v21
    s_nop 3
    s_cbranch_vccnz K_SPINL_13
K_SPINDL_14:
    s_waitcnt lgkmcnt(0)
    v_mov_b32 v20, 147472
    s_mov_b32 s50, 2097152
K_SPINS0L_15:
    ds_read_b32 v21, v20
    s_sub_u32 s50, s50, 1
    s_cmp_eq_u32 s50, 0
    s_cbranch_scc1 K_SPINDS0L_16
    s_waitcnt lgkmcnt(0)
    v_cmp_ne_u32 vcc, 1, v21
    s_nop 3
    s_cbranch_vccnz K_SPINS0L_15
K_SPINDS0L_16:
    s_waitcnt lgkmcnt(0)
    s_lshl_b32 s48, s2, 7
    s_add_u32 s48, s48, 13697032
    v_mov_b32 v20, s48
    v_mov_b32 v21, 1
    s_mov_b64 exec, 1
    buffer_store_dword v21, v20, s[12:15], 0 offen sc1
    s_mov_b64 exec, -1
K_SJD:
K_NOGATE2:
    s_cmp_lg_u32 s20, 0
    s_cbranch_scc1 K_FIN
    s_lshl_b32 s48, s21, 2
    v_add_u32 v20, s48, v1
    v_subrev_u32 v21, 112, v20
    v_min_u32 v20, v20, v21
    v_lshrrev_b32 v21, 3, v20
    v_add_u32 v21, 18, v21
    v_and_b32 v20, 7, v20
    v_lshl_add_u32 v20, v21, 3, v20
    v_lshlrev_b32 v20, 7, v20
    v_add_u32 v20, 13697032, v20
    s_mov_b32 s46, 0xf
    s_mov_b32 s47, 0
    v_mov_b32 v21, 0x40000000
    v_cndmask_b32_e64 v20, v21, v20, s[46:47]
    s_mov_b32 s49, 1
    s_mov_b32 s50, 131072
K_POLLF3_17:
    buffer_load_dword v23, v20, s[12:15], 0 offen sc1
    s_sub_u32 s50, s50, 1
    s_cmp_eq_u32 s50, 0
    s_cbranch_scc1 K_POLLDF3_18
    s_waitcnt vmcnt(0)
    v_cmp_ne_u32 vcc, s49, v23
    s_nop 3
    s_and_b64 vcc, vcc, s[46:47]
    s_cbranch_scc1 K_POLLF3_17
K_POLLDF3_18:
    s_waitcnt vmcnt(0)
    v_mov_b32 v20, 147484
    v_mov_b32 v21, 1
    ds_write_b32 v20, v21
    s_waitcnt lgkmcnt(0)
    s_branch K_FIN
K_COMPUTE:
    v_and_b32 v104, 15, v1
    v_lshrrev_b32 v105, 4, v1
    v_lshrrev_b32 v106, 1, v104
    v_xor_b32 v106, v105, v106
    s_lshl_b32 s48, s21, 13
    v_lshl_add_u32 v107, v104, 7, s48
    v_lshl_add_u32 v2, v106, 4, v107
    v_xor_b32 v3, 64, v2
    s_cmp_eq_u32 s23, 1
    s_cbranch_scc1 K_HBODY
    s_waitcnt lgkmcnt(0)
    s_mov_b32 s12, s42
    s_mov_b32 s13, s43
    s_mov_b32 s14, 13762560
    s_mov_b32 s15, 0x20000
    s_mov_b32 s96, s40
    s_mov_b32 s97, s41
    s_mov_b32 s98, 256
    s_mov_b32 s99, 0x20000
    s_lshl_b32 s48, s2, 2
    s_add_u32 s48, s48, s20
    s_cmp_lg_u32 s48, 1
    s_cbranch_scc1 K_NOCLRA
    v_lshlrev_b32 v104, 7, v1
    v_add_u32 v104, 13697024, v104
    v_mov_b32 v108, 0
    v_mov_b32 v109, 0
    v_mov_b32 v110, 0
    v_mov_b32 v111, 0
    buffer_store_dwordx4 v[108:111], v104, s[12:15], 0 offen sc1
    v_add_u32 v104, 8192, v104
    buffer_store_dwordx4 v[108:111], v104, s[12:15], 0 offen sc1
    v_add_u32 v104, 8192, v104
    buffer_store_dwordx4 v[108:111], v104, s[12:15], 0 offen sc1
    v_add_u32 v104, 8192, v104
    buffer_store_dwordx4 v[108:111], v104, s[12:15], 0 offen sc1
    v_mov_b32 v104, 0
    v_mov_b32 v105, 1
    s_waitcnt vmcnt(0)
    s_mov_b64 exec, 1
    buffer_store_dword v105, v104, s[96:99], 0 offen sc1
    s_mov_b64 exec, -1
K_NOCLRA:
    v_lshrrev_b32 v104, 2, v1
    v_mul_u32_u24 v104, 480, v104
    s_mul_i32 s48, s22, 80
    s_add_u32 s48, s48, 16384
    v_add_u32 v104, s48, v104
    v_and_b32 v105, 3, v1
    v_lshl_add_u32 v4, v105, 3, v104
    v_and_b32 v108, 1, v1
    v_mul_u32_u24 v108, 40, v108
    v_add_u32 v108, v108, v104
    v_lshrrev_b32 v109, 1, v105
    v_mul_u32_u24 v109, 160, v109
    v_add3_u32 v5, v108, v109, 32
    v_add_u32 v6, 352, v108
    v_and_b32 v96, 15, v1
    v_lshrrev_b32 v97, 4, v1
    v_lshlrev_b32 v98, 2, v97
    v_sub_u32 v98, v96, v98
    v_mov_b32 v99, 0xf149f2ca
    v_subrev_u32 v100, 0, v98
    v_and_b32 v101, 0x80000001, v100
    v_cmp_eq_u32 vcc, 0, v101
    s_nop 1
    v_cndmask_b32_e64 v8, v99, 0, vcc
    v_sub_u32 v100, -2, v100
    v_and_b32 v101, 0x80000001, v100
    v_cmp_eq_u32 vcc, 0, v101
    s_nop 1
    v_cndmask_b32_e64 v12, v99, 0, vcc
    v_subrev_u32 v100, 1, v98
    v_and_b32 v101, 0x80000001, v100
    v_cmp_eq_u32 vcc, 0, v101
    s_nop 1
    v_cndmask_b32_e64 v9, v99, 0, vcc
    v_sub_u32 v100, -2, v100
    v_and_b32 v101, 0x80000001, v100
    v_cmp_eq_u32 vcc, 0, v101
    s_nop 1
    v_cndmask_b32_e64 v13, v99, 0, vcc
    v_subrev_u32 v100, 2, v98
    v_and_b32 v101, 0x80000001, v100
    v_cmp_eq_u32 vcc, 0, v101
    s_nop 1
    v_cndmask_b32_e64 v10, v99, 0, vcc
    v_sub_u32 v100, -2, v100
    v_and_b32 v101, 0x80000001, v100
    v_cmp_eq_u32 vcc, 0, v101
    s_nop 1
    v_cndmask_b32_e64 v14, v99, 0, vcc
    v_subrev_u32 v100, 3, v98
    v_and_b32 v101, 0x80000001, v100
    v_cmp_eq_u32 vcc, 0, v101
    s_nop 1
    v_cndmask_b32_e64 v11, v99, 0, vcc
    v_sub_u32 v100, -2, v100
    v_and_b32 v101, 0x80000001, v100
    v_cmp_eq_u32 vcc, 0, v101
    s_nop 1
    v_cndmask_b32_e64 v15, v99, 0, vcc
    s_cmp_eq_u32 s21, 0
    s_cselect_b64 vcc, -1, 0
    v_cndmask_b32 v16, v12, v99, vcc
    v_cndmask_b32 v17, v13, v99, vcc
    v_cndmask_b32 v18, v14, v99, vcc
    v_cndmask_b32 v19, v15, v99, vcc
    s_lshl_b32 s48, s21, 6
    s_add_u32 s48, s48, s59
    s_cmp_eq_u32 s24, 0
    s_cselect_b32 s49, 0, 14
    s_add_u32 s49, s49, s59
    s_lshl_b32 s51, s22, 8
    s_and_b32 s58, s25, 1
    s_lshl_b32 s58, s58, 9
    s_add_u32 s51, s51, s58
    s_movk_i32 s60, 0x800
    v_add_u32 v99, s48, v96
    v_add_u32 v99, 0, v99
    v_lshrrev_b32 v100, 6, v99
    v_mul_u32_u24 v100, 4736, v100
    v_lshlrev_b32 v100, 6, v100
    v_bfe_u32 v101, v99, 4, 2
    v_lshl_add_u32 v100, v101, 10, v100
    v_and_b32 v101, 15, v99
    v_lshl_add_u32 v102, v101, 3, v100
    v_lshl_add_u32 v102, v97, 7, v102
    v_lshl_add_u32 v100, v101, 4, v100
    v_lshl_add_u32 v100, v97, 8, v100
    v_cmp_le_u32 vcc, s49, v99
    v_cmp_gt_u32 s[56:57], s60, v99
    s_nop 3
    s_and_b64 vcc, vcc, s[56:57]
    v_mov_b32 v101, 0x40000000
    v_cndmask_b32 v20, v101, v100, vcc
    v_cmp_gt_u32 s[56:57], 32, v1
    s_nop 3
    s_and_b64 vcc, vcc, s[56:57]
    v_add_u32 v100, s51, v102
    v_cndmask_b32 v24, v101, v100, vcc
    v_add_u32 v99, s48, v96
    v_add_u32 v99, 16, v99
    v_lshrrev_b32 v100, 6, v99
    v_mul_u32_u24 v100, 4736, v100
    v_lshlrev_b32 v100, 6, v100
    v_bfe_u32 v101, v99, 4, 2
    v_lshl_add_u32 v100, v101, 10, v100
    v_and_b32 v101, 15, v99
    v_lshl_add_u32 v102, v101, 3, v100
    v_lshl_add_u32 v102, v97, 7, v102
    v_lshl_add_u32 v100, v101, 4, v100
    v_lshl_add_u32 v100, v97, 8, v100
    v_cmp_le_u32 vcc, s49, v99
    v_cmp_gt_u32 s[56:57], s60, v99
    s_nop 3
    s_and_b64 vcc, vcc, s[56:57]
    v_mov_b32 v101, 0x40000000
    v_cndmask_b32 v21, v101, v100, vcc
    v_cmp_gt_u32 s[56:57], 32, v1
    s_nop 3
    s_and_b64 vcc, vcc, s[56:57]
    v_add_u32 v100, s51, v102
    v_cndmask_b32 v25, v101, v100, vcc
    v_add_u32 v99, s48, v96
    v_add_u32 v99, 32, v99
    v_lshrrev_b32 v100, 6, v99
    v_mul_u32_u24 v100, 4736, v100
    v_lshlrev_b32 v100, 6, v100
    v_bfe_u32 v101, v99, 4, 2
    v_lshl_add_u32 v100, v101, 10, v100
    v_and_b32 v101, 15, v99
    v_lshl_add_u32 v102, v101, 3, v100
    v_lshl_add_u32 v102, v97, 7, v102
    v_lshl_add_u32 v100, v101, 4, v100
    v_lshl_add_u32 v100, v97, 8, v100
    v_cmp_le_u32 vcc, s49, v99
    v_cmp_gt_u32 s[56:57], s60, v99
    s_nop 3
    s_and_b64 vcc, vcc, s[56:57]
    v_mov_b32 v101, 0x40000000
    v_cndmask_b32 v22, v101, v100, vcc
    v_cmp_gt_u32 s[56:57], 32, v1
    s_nop 3
    s_and_b64 vcc, vcc, s[56:57]
    v_add_u32 v100, s51, v102
    v_cndmask_b32 v26, v101, v100, vcc
    v_add_u32 v99, s48, v96
    v_add_u32 v99, 48, v99
    v_lshrrev_b32 v100, 6, v99
    v_mul_u32_u24 v100, 4736, v100
    v_lshlrev_b32 v100, 6, v100
    v_bfe_u32 v101, v99, 4, 2
    v_lshl_add_u32 v100, v101, 10, v100
    v_and_b32 v101, 15, v99
    v_lshl_add_u32 v102, v101, 3, v100
    v_lshl_add_u32 v102, v97, 7, v102
    v_lshl_add_u32 v100, v101, 4, v100
    v_lshl_add_u32 v100, v97, 8, v100
    v_cmp_le_u32 vcc, s49, v99
    v_cmp_gt_u32 s[56:57], s60, v99
    s_nop 3
    s_and_b64 vcc, vcc, s[56:57]
    v_mov_b32 v101, 0x40000000
    v_cndmask_b32 v23, v101, v100, vcc
    v_cmp_gt_u32 s[56:57], 32, v1
    s_nop 3
    s_and_b64 vcc, vcc, s[56:57]
    v_add_u32 v100, s51, v102
    v_cndmask_b32 v27, v101, v100, vcc
    s_lshl_b32 s48, s22, 12
    s_add_u32 s48, s48, 151552
    v_lshlrev_b32 v28, 4, v1
    v_add_u32 v28, s48, v28
    v_lshlrev_b32 v29, 3, v1
    v_add_u32 v29, s48, v29
    v_mov_b32 v30, 0x3f803f80
    v_mov_b32 v128, 0
    v_mov_b32 v129, 0
    v_mov_b32 v130, 0
    v_mov_b32 v131, 0
    v_mov_b32 v132, 0
    v_mov_b32 v133, 0
    v_mov_b32 v134, 0
    v_mov_b32 v135, 0
    v_mov_b32 v136, 0
    v_mov_b32 v137, 0
    v_mov_b32 v138, 0
    v_mov_b32 v139, 0
    v_mov_b32 v140, 0
    v_mov_b32 v141, 0
    v_mov_b32 v142, 0
    v_mov_b32 v143, 0
    v_mov_b32 v144, 0
    v_mov_b32 v145, 0
    v_mov_b32 v146, 0
    v_mov_b32 v147, 0
    v_mov_b32 v148, 0
    v_mov_b32 v149, 0
    v_mov_b32 v150, 0
    v_mov_b32 v151, 0
    v_mov_b32 v152, 0
    v_mov_b32 v153, 0
    v_mov_b32 v154, 0
    v_mov_b32 v155, 0
    v_mov_b32 v156, 0
    v_mov_b32 v157, 0
    v_mov_b32 v158, 0
    v_mov_b32 v159, 0
    v_mov_b32 v160, 0
    v_mov_b32 v161, 0
    v_mov_b32 v162, 0
    v_mov_b32 v163, 0
    v_mov_b32 v164, 0
    v_mov_b32 v165, 0
    v_mov_b32 v166, 0
    v_mov_b32 v167, 0
    v_mov_b32 v168, 0
    v_mov_b32 v169, 0
    v_mov_b32 v170, 0
    v_mov_b32 v171, 0
    v_mov_b32 v172, 0
    v_mov_b32 v173, 0
    v_mov_b32 v174, 0
    v_mov_b32 v175, 0
    v_mov_b32 v176, 0
    v_mov_b32 v177, 0
    v_mov_b32 v178, 0
    v_mov_b32 v179, 0
    v_mov_b32 v180, 0
    v_mov_b32 v181, 0
    v_mov_b32 v182, 0
    v_mov_b32 v183, 0
    v_mov_b32 v184, 0
    v_mov_b32 v185, 0
    v_mov_b32 v186, 0
    v_mov_b32 v187, 0
    v_mov_b32 v188, 0
    v_mov_b32 v189, 0
    v_mov_b32 v190, 0
    v_mov_b32 v191, 0
    v_mov_b32 v192, 0
    v_mov_b32 v193, 0
    v_mov_b32 v194, 0
    v_mov_b32 v195, 0
    v_mov_b32 v196, 0
    v_mov_b32 v197, 0
    v_mov_b32 v198, 0
    v_mov_b32 v199, 0
    v_mov_b32 v200, 0
    v_mov_b32 v201, 0
    v_mov_b32 v202, 0
    v_mov_b32 v203, 0
    v_mov_b32 v204, 0
    v_mov_b32 v205, 0
    v_mov_b32 v206, 0
    v_mov_b32 v207, 0
    v_mov_b32 v208, 0
    v_mov_b32 v209, 0
    v_mov_b32 v210, 0
    v_mov_b32 v211, 0
    v_mov_b32 v212, 0
    v_mov_b32 v213, 0
    v_mov_b32 v214, 0
    v_mov_b32 v215, 0
    v_mov_b32 v216, 0
    v_mov_b32 v217, 0
    v_mov_b32 v218, 0
    v_mov_b32 v219, 0
    v_mov_b32 v220, 0
    v_mov_b32 v221, 0
    v_mov_b32 v222, 0
    v_mov_b32 v223, 0
    v_mov_b32 v224, 0
    v_mov_b32 v225, 0
    v_mov_b32 v226, 0
    v_mov_b32 v227, 0
    v_mov_b32 v228, 0
    v_mov_b32 v229, 0
    v_mov_b32 v230, 0
    v_mov_b32 v231, 0
    v_mov_b32 v232, 0
    v_mov_b32 v233, 0
    v_mov_b32 v234, 0
    v_mov_b32 v235, 0
    v_mov_b32 v236, 0
    v_mov_b32 v237, 0
    v_mov_b32 v238, 0
    v_mov_b32 v239, 0
    v_mov_b32 v240, 0
    v_mov_b32 v241, 0
    v_mov_b32 v242, 0
    v_mov_b32 v243, 0
    v_mov_b32 v244, 0
    v_mov_b32 v245, 0
    v_mov_b32 v246, 0
    v_mov_b32 v247, 0
    v_mov_b32 v248, 0
    v_mov_b32 v249, 0
    v_mov_b32 v250, 0
    v_mov_b32 v251, 0
    v_mov_b32 v252, 0
    v_mov_b32 v253, 0
    v_mov_b32 v254, 0
    v_mov_b32 v255, 0
    s_waitcnt vmcnt(0)
    s_mov_b32 s28, 0
    s_mov_b32 s50, 9
    s_mov_b32 s30, 4
    s_barrier
    ds_read_b64_tr_b16 v[48:49], v4 offset:0
    ds_read_b64_tr_b16 v[50:51], v4 offset:7680
    ds_read_b128 v[32:35], v2 offset:0
    ds_read_b128 v[36:39], v2 offset:2048
    ds_read_b128 v[40:43], v2 offset:4096
    ds_read_b128 v[44:47], v2 offset:6144
    ds_read_b64_tr_b16 v[52:53], v4 offset:160
    ds_read_b64_tr_b16 v[54:55], v4 offset:7840
    ds_read_b64_tr_b16 v[56:57], v4 offset:320
    ds_read_b64_tr_b16 v[58:59], v4 offset:8000
    ds_read_b64_tr_b16 v[60:61], v4 offset:40
    ds_read_b64_tr_b16 v[62:63], v4 offset:7720
    ds_read_b64_tr_b16 v[64:65], v4 offset:200
    ds_read_b64_tr_b16 v[66:67], v4 offset:7880
    ds_read_b64_tr_b16 v[68:69], v4 offset:360
    ds_read_b64_tr_b16 v[70:71], v4 offset:8040
    ds_read_b64_tr_b16 v[72:73], v5 offset:0
    ds_read_b64_tr_b16 v[74:75], v5 offset:7680
    ds_read_b64_tr_b16 v[76:77], v6 offset:0
    ds_read_b64_tr_b16 v[78:79], v6 offset:7680
    s_waitcnt lgkmcnt(0)
.p2align 3
K_LOOPA:
    s_add_u32 s49, s28, 49152
    s_cmp_eq_u32 s49, 147456
    s_cselect_b32 s49, 0, s49
    s_sub_u32 s29, s49, s28
    s_mov_b32 s28, s49
    v_mfma_f32_16x16x32_bf16 v[128:131], v[48:51], v[32:35], v[128:131]
    ds_read_b64_tr_b16 v[96:97], v4 offset:15360
    v_mfma_f32_16x16x32_bf16 v[160:163], v[48:51], v[36:39], v[160:163]
    ds_read_b64_tr_b16 v[98:99], v4 offset:23040
    v_mfma_f32_16x16x32_bf16 v[192:195], v[48:51], v[40:43], v[192:195]
    ds_read_b128 v[80:83], v3 offset:0
    v_mfma_f32_16x16x32_bf16 v[224:227], v[48:51], v[44:47], v[224:227]
    ds_read_b128 v[84:87], v3 offset:2048
    v_mfma_f32_16x16x32_bf16 v[132:135], v[52:55], v[32:35], v[132:135]
    ds_read_b128 v[88:91], v3 offset:4096
    v_mfma_f32_16x16x32_bf16 v[164:167], v[52:55], v[36:39], v[164:167]
    ds_read_b128 v[92:95], v3 offset:6144
    v_mfma_f32_16x16x32_bf16 v[196:199], v[52:55], v[40:43], v[196:199]
    ds_read_b64_tr_b16 v[100:101], v4 offset:15520
    v_mfma_f32_16x16x32_bf16 v[228:231], v[52:55], v[44:47], v[228:231]
    ds_read_b64_tr_b16 v[102:103], v4 offset:23200
    v_mfma_f32_16x16x32_bf16 v[136:139], v[32:35], v[56:59], v[136:139]
    ds_read_b64_tr_b16 v[104:105], v4 offset:15680
    v_mfma_f32_16x16x32_bf16 v[168:171], v[36:39], v[56:59], v[168:171]
    ds_read_b64_tr_b16 v[106:107], v4 offset:23360
    v_mfma_f32_16x16x32_bf16 v[200:203], v[40:43], v[56:59], v[200:203]
    ds_read_b64_tr_b16 v[108:109], v4 offset:15400
    v_mfma_f32_16x16x32_bf16 v[232:235], v[44:47], v[56:59], v[232:235]
    ds_read_b64_tr_b16 v[110:111], v4 offset:23080
    v_mfma_f32_16x16x32_bf16 v[140:143], v[60:63], v[32:35], v[140:143]
    ds_read_b64_tr_b16 v[112:113], v4 offset:15560
    v_mfma_f32_16x16x32_bf16 v[172:175], v[60:63], v[36:39], v[172:175]
    ds_read_b64_tr_b16 v[114:115], v4 offset:23240
    v_mfma_f32_16x16x32_bf16 v[204:207], v[60:63], v[40:43], v[204:207]
    ds_read_b64_tr_b16 v[116:117], v4 offset:15720
    v_mfma_f32_16x16x32_bf16 v[236:239], v[60:63], v[44:47], v[236:239]
    ds_read_b64_tr_b16 v[118:119], v4 offset:23400
    v_mfma_f32_16x16x32_bf16 v[144:147], v[64:67], v[32:35], v[144:147]
    ds_read_b64_tr_b16 v[120:121], v5 offset:15360
    v_mfma_f32_16x16x32_bf16 v[176:179], v[64:67], v[36:39], v[176:179]
    ds_read_b64_tr_b16 v[122:123], v5 offset:23040
    v_mfma_f32_16x16x32_bf16 v[208:211], v[64:67], v[40:43], v[208:211]
    ds_read_b64_tr_b16 v[124:125], v6 offset:15360
    v_mfma_f32_16x16x32_bf16 v[240:243], v[64:67], v[44:47], v[240:243]
    ds_read_b64_tr_b16 v[126:127], v6 offset:23040
    v_mfma_f32_16x16x32_bf16 v[148:151], v[32:35], v[68:71], v[148:151]
    v_add_u32 v2, s29, v2
    v_add_u32 v3, s29, v3
    v_add_u32 v4, s29, v4
    v_add_u32 v5, s29, v5
    v_add_u32 v6, s29, v6
    v_mfma_f32_16x16x32_bf16 v[180:183], v[36:39], v[68:71], v[180:183]
    v_mfma_f32_16x16x32_bf16 v[212:215], v[40:43], v[68:71], v[212:215]
    v_mfma_f32_16x16x32_bf16 v[244:247], v[44:47], v[68:71], v[244:247]
    v_mfma_f32_16x16x32_bf16 v[152:155], v[72:75], v[32:35], v[152:155]
    v_mfma_f32_16x16x32_bf16 v[184:187], v[72:75], v[36:39], v[184:187]
    v_mfma_f32_16x16x32_bf16 v[216:219], v[72:75], v[40:43], v[216:219]
    v_mfma_f32_16x16x32_bf16 v[248:251], v[72:75], v[44:47], v[248:251]
    v_mfma_f32_16x16x32_bf16 v[156:159], v[32:35], v[76:79], v[156:159]
    v_mfma_f32_16x16x32_bf16 v[188:191], v[36:39], v[76:79], v[188:191]
    v_mfma_f32_16x16x32_bf16 v[220:223], v[40:43], v[76:79], v[220:223]
    v_mfma_f32_16x16x32_bf16 v[252:255], v[44:47], v[76:79], v[252:255]
    s_waitcnt lgkmcnt(0)
    s_barrier
    v_mfma_f32_16x16x32_bf16 v[128:131], v[96:99], v[80:83], v[128:131]
    ds_read_b64_tr_b16 v[48:49], v4 offset:0
    v_mfma_f32_16x16x32_bf16 v[160:163], v[96:99], v[84:87], v[160:163]
    ds_read_b64_tr_b16 v[50:51], v4 offset:7680
    v_mfma_f32_16x16x32_bf16 v[192:195], v[96:99], v[88:91], v[192:195]
    ds_read_b128 v[32:35], v2 offset:0
    v_mfma_f32_16x16x32_bf16 v[224:227], v[96:99], v[92:95], v[224:227]
    ds_read_b128 v[36:39], v2 offset:2048
    v_mfma_f32_16x16x32_bf16 v[132:135], v[100:103], v[80:83], v[132:135]
    ds_read_b128 v[40:43], v2 offset:4096
    v_mfma_f32_16x16x32_bf16 v[164:167], v[100:103], v[84:87], v[164:167]
    ds_read_b128 v[44:47], v2 offset:6144
    v_mfma_f32_16x16x32_bf16 v[196:199], v[100:103], v[88:91], v[196:199]
    ds_read_b64_tr_b16 v[52:53], v4 offset:160
    v_mfma_f32_16x16x32_bf16 v[228:231], v[100:103], v[92:95], v[228:231]
    ds_read_b64_tr_b16 v[54:55], v4 offset:7840
    v_mfma_f32_16x16x32_bf16 v[136:139], v[80:83], v[104:107], v[136:139]
    ds_read_b64_tr_b16 v[56:57], v4 offset:320
    v_mfma_f32_16x16x32_bf16 v[168:171], v[84:87], v[104:107], v[168:171]
    ds_read_b64_tr_b16 v[58:59], v4 offset:8000
    v_mfma_f32_16x16x32_bf16 v[200:203], v[88:91], v[104:107], v[200:203]
    ds_read_b64_tr_b16 v[60:61], v4 offset:40
    v_mfma_f32_16x16x32_bf16 v[232:235], v[92:95], v[104:107], v[232:235]
    ds_read_b64_tr_b16 v[62:63], v4 offset:7720
    v_mfma_f32_16x16x32_bf16 v[140:143], v[108:111], v[80:83], v[140:143]
    ds_read_b64_tr_b16 v[64:65], v4 offset:200
    v_mfma_f32_16x16x32_bf16 v[172:175], v[108:111], v[84:87], v[172:175]
    ds_read_b64_tr_b16 v[66:67], v4 offset:7880
    v_mfma_f32_16x16x32_bf16 v[204:207], v[108:111], v[88:91], v[204:207]
    ds_read_b64_tr_b16 v[68:69], v4 offset:360
    v_mfma_f32_16x16x32_bf16 v[236:239], v[108:111], v[92:95], v[236:239]
    ds_read_b64_tr_b16 v[70:71], v4 offset:8040
    v_mfma_f32_16x16x32_bf16 v[144:147], v[112:115], v[80:83], v[144:147]
    ds_read_b64_tr_b16 v[72:73], v5 offset:0
    v_mfma_f32_16x16x32_bf16 v[176:179], v[112:115], v[84:87], v[176:179]
    ds_read_b64_tr_b16 v[74:75], v5 offset:7680
    v_mfma_f32_16x16x32_bf16 v[208:211], v[112:115], v[88:91], v[208:211]
    ds_read_b64_tr_b16 v[76:77], v6 offset:0
    v_mfma_f32_16x16x32_bf16 v[240:243], v[112:115], v[92:95], v[240:243]
    ds_read_b64_tr_b16 v[78:79], v6 offset:7680
    v_mfma_f32_16x16x32_bf16 v[148:151], v[80:83], v[116:119], v[148:151]
    v_mfma_f32_16x16x32_bf16 v[180:183], v[84:87], v[116:119], v[180:183]
    v_mfma_f32_16x16x32_bf16 v[212:215], v[88:91], v[116:119], v[212:215]
    v_mfma_f32_16x16x32_bf16 v[244:247], v[92:95], v[116:119], v[244:247]
    v_mfma_f32_16x16x32_bf16 v[152:155], v[120:123], v[80:83], v[152:155]
    v_mfma_f32_16x16x32_bf16 v[184:187], v[120:123], v[84:87], v[184:187]
    v_mfma_f32_16x16x32_bf16 v[216:219], v[120:123], v[88:91], v[216:219]
    v_mfma_f32_16x16x32_bf16 v[248:251], v[120:123], v[92:95], v[248:251]
    v_mfma_f32_16x16x32_bf16 v[156:159], v[80:83], v[124:127], v[156:159]
    v_mfma_f32_16x16x32_bf16 v[188:191], v[84:87], v[124:127], v[188:191]
    v_mfma_f32_16x16x32_bf16 v[220:223], v[88:91], v[124:127], v[220:223]
    v_mfma_f32_16x16x32_bf16 v[252:255], v[92:95], v[124:127], v[252:255]
    s_waitcnt lgkmcnt(0)
    s_sub_u32 s50, s50, 1
    s_cmp_lg_u32 s50, 0
    s_cbranch_scc1 K_LOOPA
    v_mfma_f32_16x16x32_bf16 v[128:131], v[48:51], v[32:35], v[128:131]
    ds_read_b64_tr_b16 v[96:97], v4 offset:15360
    v_mfma_f32_16x16x32_bf16 v[160:163], v[48:51], v[36:39], v[160:163]
    ds_read_b64_tr_b16 v[98:99], v4 offset:23040
    v_mfma_f32_16x16x32_bf16 v[192:195], v[48:51], v[40:43], v[192:195]
    ds_read_b128 v[80:83], v3 offset:0
    v_mfma_f32_16x16x32_bf16 v[224:227], v[48:51], v[44:47], v[224:227]
    ds_read_b128 v[84:87], v3 offset:2048
    v_mfma_f32_16x16x32_bf16 v[132:135], v[52:55], v[32:35], v[132:135]
    ds_read_b128 v[88:91], v3 offset:4096
    v_mfma_f32_16x16x32_bf16 v[164:167], v[52:55], v[36:39], v[164:167]
    ds_read_b128 v[92:95], v3 offset:6144
    v_mfma_f32_16x16x32_bf16 v[196:199], v[52:55], v[40:43], v[196:199]
    ds_read_b64_tr_b16 v[100:101], v4 offset:15520
    v_mfma_f32_16x16x32_bf16 v[228:231], v[52:55], v[44:47], v[228:231]
    ds_read_b64_tr_b16 v[102:103], v4 offset:23200
    v_mfma_f32_16x16x32_bf16 v[136:139], v[32:35], v[56:59], v[136:139]
    ds_read_b64_tr_b16 v[104:105], v4 offset:15680
    v_mfma_f32_16x16x32_bf16 v[168:171], v[36:39], v[56:59], v[168:171]
    ds_read_b64_tr_b16 v[106:107], v4 offset:23360
    v_mfma_f32_16x16x32_bf16 v[200:203], v[40:43], v[56:59], v[200:203]
    ds_read_b64_tr_b16 v[108:109], v4 offset:15400
    v_mfma_f32_16x16x32_bf16 v[232:235], v[44:47], v[56:59], v[232:235]
    ds_read_b64_tr_b16 v[110:111], v4 offset:23080
    v_mfma_f32_16x16x32_bf16 v[140:143], v[60:63], v[32:35], v[140:143]
    ds_read_b64_tr_b16 v[112:113], v4 offset:15560
    v_mfma_f32_16x16x32_bf16 v[172:175], v[60:63], v[36:39], v[172:175]
    ds_read_b64_tr_b16 v[114:115], v4 offset:23240
    v_mfma_f32_16x16x32_bf16 v[204:207], v[60:63], v[40:43], v[204:207]
    ds_read_b64_tr_b16 v[116:117], v4 offset:15720
    v_mfma_f32_16x16x32_bf16 v[236:239], v[60:63], v[44:47], v[236:239]
    ds_read_b64_tr_b16 v[118:119], v4 offset:23400
    v_mfma_f32_16x16x32_bf16 v[144:147], v[64:67], v[32:35], v[144:147]
    ds_read_b64_tr_b16 v[120:121], v5 offset:15360
    v_mfma_f32_16x16x32_bf16 v[176:179], v[64:67], v[36:39], v[176:179]
    ds_read_b64_tr_b16 v[122:123], v5 offset:23040
    v_mfma_f32_16x16x32_bf16 v[208:211], v[64:67], v[40:43], v[208:211]
    ds_read_b64_tr_b16 v[124:125], v6 offset:15360
    v_mfma_f32_16x16x32_bf16 v[240:243], v[64:67], v[44:47], v[240:243]
    ds_read_b64_tr_b16 v[126:127], v6 offset:23040
    v_mfma_f32_16x16x32_bf16 v[148:151], v[32:35], v[68:71], v[148:151]
    v_mfma_f32_16x16x32_bf16 v[180:183], v[36:39], v[68:71], v[180:183]
    v_mfma_f32_16x16x32_bf16 v[212:215], v[40:43], v[68:71], v[212:215]
    v_mfma_f32_16x16x32_bf16 v[244:247], v[44:47], v[68:71], v[244:247]
    v_mfma_f32_16x16x32_bf16 v[152:155], v[72:75], v[32:35], v[152:155]
    v_mfma_f32_16x16x32_bf16 v[184:187], v[72:75], v[36:39], v[184:187]
    v_mfma_f32_16x16x32_bf16 v[216:219], v[72:75], v[40:43], v[216:219]
    v_mfma_f32_16x16x32_bf16 v[248:251], v[72:75], v[44:47], v[248:251]
    v_mfma_f32_16x16x32_bf16 v[156:159], v[32:35], v[76:79], v[156:159]
    v_mfma_f32_16x16x32_bf16 v[188:191], v[36:39], v[76:79], v[188:191]
    v_mfma_f32_16x16x32_bf16 v[220:223], v[40:43], v[76:79], v[220:223]
    v_mfma_f32_16x16x32_bf16 v[252:255], v[44:47], v[76:79], v[252:255]
    s_waitcnt lgkmcnt(0)
    v_mov_b32 v32, 147480
    v_mov_b32 v33, 1
    s_mov_b64 exec, 1
    ds_add_u32 v32, v33
    s_mov_b64 exec, -1
    v_mfma_f32_16x16x32_bf16 v[128:131], v[96:99], v[80:83], v[128:131]
    v_mfma_f32_16x16x32_bf16 v[160:163], v[96:99], v[84:87], v[160:163]
    v_mfma_f32_16x16x32_bf16 v[192:195], v[96:99], v[88:91], v[192:195]
    v_mfma_f32_16x16x32_bf16 v[224:227], v[96:99], v[92:95], v[224:227]
    v_mfma_f32_16x16x32_bf16 v[132:135], v[100:103], v[80:83], v[132:135]
    v_mfma_f32_16x16x32_bf16 v[164:167], v[100:103], v[84:87], v[164:167]
    v_mfma_f32_16x16x32_bf16 v[196:199], v[100:103], v[88:91], v[196:199]
    v_mfma_f32_16x16x32_bf16 v[228:231], v[100:103], v[92:95], v[228:231]
    v_mfma_f32_16x16x32_bf16 v[136:139], v[80:83], v[104:107], v[136:139]
    v_mfma_f32_16x16x32_bf16 v[168:171], v[84:87], v[104:107], v[168:171]
    v_mfma_f32_16x16x32_bf16 v[200:203], v[88:91], v[104:107], v[200:203]
    v_mfma_f32_16x16x32_bf16 v[232:235], v[92:95], v[104:107], v[232:235]
    v_mfma_f32_16x16x32_bf16 v[140:143], v[108:111], v[80:83], v[140:143]
    v_mfma_f32_16x16x32_bf16 v[172:175], v[108:111], v[84:87], v[172:175]
    v_mfma_f32_16x16x32_bf16 v[204:207], v[108:111], v[88:91], v[204:207]
    v_mfma_f32_16x16x32_bf16 v[236:239], v[108:111], v[92:95], v[236:239]
    v_mfma_f32_16x16x32_bf16 v[144:147], v[112:115], v[80:83], v[144:147]
    v_mfma_f32_16x16x32_bf16 v[176:179], v[112:115], v[84:87], v[176:179]
    v_mfma_f32_16x16x32_bf16 v[208:211], v[112:115], v[88:91], v[208:211]
    v_mfma_f32_16x16x32_bf16 v[240:243], v[112:115], v[92:95], v[240:243]
    v_mfma_f32_16x16x32_bf16 v[148:151], v[80:83], v[116:119], v[148:151]
    v_mfma_f32_16x16x32_bf16 v[180:183], v[84:87], v[116:119], v[180:183]
    v_mfma_f32_16x16x32_bf16 v[212:215], v[88:91], v[116:119], v[212:215]
    v_mfma_f32_16x16x32_bf16 v[244:247], v[92:95], v[116:119], v[244:247]
    v_mfma_f32_16x16x32_bf16 v[152:155], v[120:123], v[80:83], v[152:155]
    v_mfma_f32_16x16x32_bf16 v[184:187], v[120:123], v[84:87], v[184:187]
    v_mfma_f32_16x16x32_bf16 v[216:219], v[120:123], v[88:91], v[216:219]
    v_mfma_f32_16x16x32_bf16 v[248:251], v[120:123], v[92:95], v[248:251]
    v_mfma_f32_16x16x32_bf16 v[156:159], v[80:83], v[124:127], v[156:159]
    v_mfma_f32_16x16x32_bf16 v[188:191], v[84:87], v[124:127], v[188:191]
    v_mfma_f32_16x16x32_bf16 v[220:223], v[88:91], v[124:127], v[220:223]
    v_mfma_f32_16x16x32_bf16 v[252:255], v[92:95], v[124:127], v[252:255]
    s_mov_b32 s40, 0xffff
    s_mov_b32 s41, 0
    s_mov_b32 s42, 0xffff0000
    s_mov_b32 s43, 0
    s_mov_b32 s44, 0xff00ff00
    s_mov_b32 s45, 0xff00ff00
    s_mov_b32 s62, 0x3ea52b5c
    s_mov_b32 s63, 0x3ea52b5c
    s_lshl_b32 s60, s25, 1
    s_add_u32 s60, s60, s22
    s_add_u32 s60, s60, 54
    s_lshl_b32 s60, s60, 12
    s_lshr_b32 s61, s25, 1
    s_add_u32 s61, s61, 70
    s_lshl_b32 s61, s61, 12
    s_nop 7
    v_cvt_pk_bf16_f32 v56, v228, v229
    v_cvt_pk_bf16_f32 v57, v230, v231
    v_cvt_pk_bf16_f32 v60, v240, v241
    v_cvt_pk_bf16_f32 v61, v242, v243
    v_cvt_pk_bf16_f32 v124, v248, v249
    v_cvt_pk_bf16_f32 v125, v250, v251
    v_cvt_pk_bf16_f32 v70, v232, v233
    v_cvt_pk_bf16_f32 v71, v234, v235
    v_mov_b32 v58, v124
    v_mov_b32 v59, v125
    v_cndmask_b32_e64 v118, 0, v124, s[40:41]
    v_cndmask_b32_e64 v119, 0, v125, s[40:41]
    v_cndmask_b32_e64 v120, 0, v124, s[42:43]
    v_cndmask_b32_e64 v121, 0, v125, s[42:43]
    v_permlane32_swap_b32 v124, v58
    v_permlane32_swap_b32 v125, v59
    v_cvt_pk_bf16_f32 v80, v244, v245
    v_cvt_pk_bf16_f32 v81, v246, v247
    v_cvt_pk_bf16_f32 v90, v252, v253
    v_cvt_pk_bf16_f32 v91, v254, v255
    v_cvt_pk_bf16_f32 v116, v224, v225
    v_cvt_pk_bf16_f32 v117, v226, v227
    v_cvt_pk_bf16_f32 v122, v236, v237
    v_cvt_pk_bf16_f32 v123, v238, v239
    v_cndmask_b32_e64 v90, v90, v30, s[44:45]
    v_cndmask_b32_e64 v91, v91, v30, s[44:45]
    s_lshl_b32 s48, s22, 2
    s_add_u32 s48, s48, 147456
    v_mov_b32 v2, s48
    s_cmp_eq_u32 s21, 0
    s_cbranch_scc0 K_NOHW
    ds_write_b128 v28, v[56:59]
    ds_write_b64 v29, v[60:61] offset:1024
    ds_write_b64 v29, v[70:71] offset:1536
    ds_write_b64 v29, v[80:81] offset:2048
    ds_write_b64 v29, v[90:91] offset:2560
    v_mov_b32 v3, 1
    s_waitcnt lgkmcnt(0)
    ds_write_b32 v2, v3
K_NOHW:
    v_cvt_pk_bf16_f32 v38, v132, v133
    v_cvt_pk_bf16_f32 v39, v134, v135
    v_cvt_pk_bf16_f32 v42, v144, v145
    v_cvt_pk_bf16_f32 v43, v146, v147
    v_cvt_pk_bf16_f32 v124, v152, v153
    v_cvt_pk_bf16_f32 v125, v154, v155
    v_cvt_pk_bf16_f32 v64, v136, v137
    v_cvt_pk_bf16_f32 v65, v138, v139
    v_mov_b32 v40, v124
    v_mov_b32 v41, v125
    v_cndmask_b32_e64 v94, 0, v124, s[40:41]
    v_cndmask_b32_e64 v95, 0, v125, s[40:41]
    v_cndmask_b32_e64 v96, 0, v124, s[42:43]
    v_cndmask_b32_e64 v97, 0, v125, s[42:43]
    v_permlane32_swap_b32 v124, v40
    v_permlane32_swap_b32 v125, v41
    v_cvt_pk_bf16_f32 v74, v148, v149
    v_cvt_pk_bf16_f32 v75, v150, v151
    v_cvt_pk_bf16_f32 v84, v156, v157
    v_cvt_pk_bf16_f32 v85, v158, v159
    v_cvt_pk_bf16_f32 v92, v128, v129
    v_cvt_pk_bf16_f32 v93, v130, v131
    v_cvt_pk_bf16_f32 v98, v140, v141
    v_cvt_pk_bf16_f32 v99, v142, v143
    v_cndmask_b32_e64 v84, v84, v30, s[44:45]
    v_cndmask_b32_e64 v85, v85, v30, s[44:45]
    v_cvt_pk_bf16_f32 v44, v164, v165
    v_cvt_pk_bf16_f32 v45, v166, v167
    v_cvt_pk_bf16_f32 v48, v176, v177
    v_cvt_pk_bf16_f32 v49, v178, v179
    v_cvt_pk_bf16_f32 v124, v184, v185
    v_cvt_pk_bf16_f32 v125, v186, v187
    v_cvt_pk_bf16_f32 v66, v168, v169
    v_cvt_pk_bf16_f32 v67, v170, v171
    v_mov_b32 v46, v124
    v_mov_b32 v47, v125
    v_cndmask_b32_e64 v102, 0, v124, s[40:41]
    v_cndmask_b32_e64 v103, 0, v125, s[40:41]
    v_cndmask_b32_e64 v104, 0, v124, s[42:43]
    v_cndmask_b32_e64 v105, 0, v125, s[42:43]
    v_permlane32_swap_b32 v124, v46
    v_permlane32_swap_b32 v125, v47
    v_cvt_pk_bf16_f32 v76, v180, v181
    v_cvt_pk_bf16_f32 v77, v182, v183
    v_cvt_pk_bf16_f32 v86, v188, v189
    v_cvt_pk_bf16_f32 v87, v190, v191
    v_cvt_pk_bf16_f32 v100, v160, v161
    v_cvt_pk_bf16_f32 v101, v162, v163
    v_cvt_pk_bf16_f32 v106, v172, v173
    v_cvt_pk_bf16_f32 v107, v174, v175
    v_cndmask_b32_e64 v86, v86, v30, s[44:45]
    v_cndmask_b32_e64 v87, v87, v30, s[44:45]
    v_cvt_pk_bf16_f32 v50, v196, v197
    v_cvt_pk_bf16_f32 v51, v198, v199
    v_cvt_pk_bf16_f32 v54, v208, v209
    v_cvt_pk_bf16_f32 v55, v210, v211
    v_cvt_pk_bf16_f32 v124, v216, v217
    v_cvt_pk_bf16_f32 v125, v218, v219
    v_cvt_pk_bf16_f32 v68, v200, v201
    v_cvt_pk_bf16_f32 v69, v202, v203
    v_mov_b32 v52, v124
    v_mov_b32 v53, v125
    v_cndmask_b32_e64 v110, 0, v124, s[40:41]
    v_cndmask_b32_e64 v111, 0, v125, s[40:41]
    v_cndmask_b32_e64 v112, 0, v124, s[42:43]
    v_cndmask_b32_e64 v113, 0, v125, s[42:43]
    v_permlane32_swap_b32 v124, v52
    v_permlane32_swap_b32 v125, v53
    v_cvt_pk_bf16_f32 v78, v212, v213
    v_cvt_pk_bf16_f32 v79, v214, v215
    v_cvt_pk_bf16_f32 v88, v220, v221
    v_cvt_pk_bf16_f32 v89, v222, v223
    v_cvt_pk_bf16_f32 v108, v192, v193
    v_cvt_pk_bf16_f32 v109, v194, v195
    v_cvt_pk_bf16_f32 v114, v204, v205
    v_cvt_pk_bf16_f32 v115, v206, v207
    v_cndmask_b32_e64 v88, v88, v30, s[44:45]
    v_cndmask_b32_e64 v89, v89, v30, s[44:45]
    v_mfma_f32_16x16x32_bf16 v[128:131], v[38:41], v[100:103], v[12:15]
    v_mfma_f32_16x16x32_bf16 v[132:135], v[44:47], v[100:103], v[8:11]
    v_mfma_f32_16x16x32_bf16 v[136:139], v[40:43], v[104:107], v[12:15]
    v_mfma_f32_16x16x32_bf16 v[140:143], v[46:49], v[104:107], v[8:11]
    v_mfma_f32_16x16x32_bf16 v[144:147], v[44:47], v[108:111], v[12:15]
    v_mfma_f32_16x16x32_bf16 v[148:151], v[50:53], v[108:111], v[8:11]
    v_mfma_f32_16x16x32_bf16 v[152:155], v[46:49], v[112:115], v[12:15]
    v_mfma_f32_16x16x32_bf16 v[156:159], v[52:55], v[112:115], v[8:11]
    s_nop 0
    v_max3_f32 v208, v128, v129, v130
    s_nop 0
    v_max3_f32 v209, v136, v137, v138
    s_nop 0
    v_max3_f32 v210, v144, v145, v146
    s_nop 0
    v_max3_f32 v211, v152, v153, v154
    v_max3_f32 v208, v208, v131, v132
    v_max3_f32 v209, v209, v139, v140
    v_max3_f32 v210, v210, v147, v148
    v_max3_f32 v211, v211, v155, v156
    v_max3_f32 v208, v208, v133, v134
    v_max3_f32 v209, v209, v141, v142
    v_max3_f32 v210, v210, v149, v150
    v_max3_f32 v211, v211, v157, v158
    v_max_f32 v208, v208, v135
    v_max_f32 v209, v209, v143
    v_max_f32 v210, v210, v151
    v_max_f32 v211, v211, v159
    v_permlane32_swap_b32 v208, v209
    s_nop 0
    v_permlane32_swap_b32 v210, v211
    v_max_f32 v208, v208, v209
    v_max_f32 v210, v210, v211
    s_nop 1
    v_permlane16_swap_b32 v208, v210
    v_max_f32 v208, v208, v210
    v_mul_f32 v224, 0xbea52b5c, v208
    v_mov_b32 v226, v224
    s_nop 1
    v_permlane32_swap_b32 v224, v226
    v_mov_b32 v228, v224
    v_mov_b32 v230, v226
    s_nop 0
    v_permlane16_swap_b32 v224, v228
    v_permlane16_swap_b32 v226, v230
    v_pk_fma_f32 v[128:129], v[128:129], s[62:63], v[224:225] op_sel_hi:[1,1,0]
    v_pk_fma_f32 v[130:131], v[130:131], s[62:63], v[224:225] op_sel_hi:[1,1,0]
    v_pk_fma_f32 v[132:133], v[132:133], s[62:63], v[224:225] op_sel_hi:[1,1,0]
    v_pk_fma_f32 v[134:135], v[134:135], s[62:63], v[224:225] op_sel_hi:[1,1,0]
    v_pk_fma_f32 v[136:137], v[136:137], s[62:63], v[226:227] op_sel_hi:[1,1,0]
    v_pk_fma_f32 v[138:139], v[138:139], s[62:63], v[226:227] op_sel_hi:[1,1,0]
    v_pk_fma_f32 v[140:141], v[140:141], s[62:63], v[226:227] op_sel_hi:[1,1,0]
    v_pk_fma_f32 v[142:143], v[142:143], s[62:63], v[226:227] op_sel_hi:[1,1,0]
    v_pk_fma_f32 v[144:145], v[144:145], s[62:63], v[228:229] op_sel_hi:[1,1,0]
    v_pk_fma_f32 v[146:147], v[146:147], s[62:63], v[228:229] op_sel_hi:[1,1,0]
    v_pk_fma_f32 v[148:149], v[148:149], s[62:63], v[228:229] op_sel_hi:[1,1,0]
    v_pk_fma_f32 v[150:151], v[150:151], s[62:63], v[228:229] op_sel_hi:[1,1,0]
    v_pk_fma_f32 v[152:153], v[152:153], s[62:63], v[230:231] op_sel_hi:[1,1,0]
    v_pk_fma_f32 v[154:155], v[154:155], s[62:63], v[230:231] op_sel_hi:[1,1,0]
    v_pk_fma_f32 v[156:157], v[156:157], s[62:63], v[230:231] op_sel_hi:[1,1,0]
    v_pk_fma_f32 v[158:159], v[158:159], s[62:63], v[230:231] op_sel_hi:[1,1,0]
    v_exp_f32 v128, v128
    v_exp_f32 v129, v129
    v_exp_f32 v130, v130
    v_exp_f32 v131, v131
    v_exp_f32 v132, v132
    v_exp_f32 v133, v133
    v_exp_f32 v134, v134
    v_exp_f32 v135, v135
    v_exp_f32 v136, v136
    v_exp_f32 v137, v137
    v_exp_f32 v138, v138
    v_exp_f32 v139, v139
    v_exp_f32 v140, v140
    v_exp_f32 v141, v141
    v_exp_f32 v142, v142
    v_exp_f32 v143, v143
    v_cvt_pk_bf16_f32 v160, v128, v129
    v_cvt_pk_bf16_f32 v161, v130, v131
    v_cvt_pk_bf16_f32 v162, v132, v133
    v_cvt_pk_bf16_f32 v163, v134, v135
    v_exp_f32 v144, v144
    v_exp_f32 v145, v145
    v_exp_f32 v146, v146
    v_exp_f32 v147, v147
    v_exp_f32 v148, v148
    v_exp_f32 v149, v149
    v_exp_f32 v150, v150
    v_exp_f32 v151, v151
    v_cvt_pk_bf16_f32 v164, v136, v137
    v_cvt_pk_bf16_f32 v165, v138, v139
    v_cvt_pk_bf16_f32 v166, v140, v141
    v_cvt_pk_bf16_f32 v167, v142, v143
    v_exp_f32 v152, v152
    v_exp_f32 v153, v153
    v_exp_f32 v154, v154
    v_exp_f32 v155, v155
    v_exp_f32 v156, v156
    v_exp_f32 v157, v157
    v_exp_f32 v158, v158
    v_exp_f32 v159, v159
    v_cvt_pk_bf16_f32 v168, v144, v145
    v_cvt_pk_bf16_f32 v169, v146, v147
    v_cvt_pk_bf16_f32 v170, v148, v149
    v_cvt_pk_bf16_f32 v171, v150, v151
    v_cvt_pk_bf16_f32 v172, v152, v153
    v_cvt_pk_bf16_f32 v173, v154, v155
    v_cvt_pk_bf16_f32 v174, v156, v157
    v_cvt_pk_bf16_f32 v175, v158, v159
    v_mfma_f32_16x16x32_bf16 v[192:195], v[84:87], v[160:163], 0
    v_mfma_f32_16x16x32_bf16 v[176:179], v[64:67], v[160:163], 0
    v_mfma_f32_16x16x32_bf16 v[196:199], v[84:87], v[164:167], 0
    v_mfma_f32_16x16x32_bf16 v[180:183], v[74:77], v[164:167], 0
    v_mfma_f32_16x16x32_bf16 v[200:203], v[86:89], v[168:171], 0
    v_mfma_f32_16x16x32_bf16 v[184:187], v[66:69], v[168:171], 0
    v_mfma_f32_16x16x32_bf16 v[204:207], v[86:89], v[172:175], 0
    v_mfma_f32_16x16x32_bf16 v[188:191], v[76:79], v[172:175], 0
    s_nop 0
    v_mov_b32 v216, v192
    s_nop 0
    v_mov_b32 v218, v196
    s_nop 0
    v_mov_b32 v220, v200
    s_nop 0
    v_mov_b32 v222, v204
    v_permlane32_swap_b32 v193, v216
    v_permlane32_swap_b32 v197, v218
    v_permlane32_swap_b32 v201, v220
    v_permlane32_swap_b32 v205, v222
    v_rcp_f32 v216, v216
    v_rcp_f32 v218, v218
    v_rcp_f32 v220, v220
    v_rcp_f32 v222, v222
    v_pk_mul_f32 v[176:177], v[176:177], v[216:217] op_sel_hi:[1,0]
    v_pk_mul_f32 v[178:179], v[178:179], v[216:217] op_sel_hi:[1,0]
    v_pk_mul_f32 v[192:193], v[192:193], v[216:217] op_sel_hi:[1,0]
    v_pk_mul_f32 v[194:195], v[194:195], v[216:217] op_sel_hi:[1,0]
    v_cvt_pk_bf16_f32 v232, v176, v177
    v_cvt_pk_bf16_f32 v233, v178, v179
    v_cvt_pk_bf16_f32 v240, v192, v193
    v_cvt_pk_bf16_f32 v241, v194, v195
    v_pk_mul_f32 v[180:181], v[180:181], v[218:219] op_sel_hi:[1,0]
    v_pk_mul_f32 v[182:183], v[182:183], v[218:219] op_sel_hi:[1,0]
    v_pk_mul_f32 v[196:197], v[196:197], v[218:219] op_sel_hi:[1,0]
    v_pk_mul_f32 v[198:199], v[198:199], v[218:219] op_sel_hi:[1,0]
    v_cvt_pk_bf16_f32 v234, v180, v181
    v_cvt_pk_bf16_f32 v235, v182, v183
    v_cvt_pk_bf16_f32 v242, v196, v197
    v_cvt_pk_bf16_f32 v243, v198, v199
    v_pk_mul_f32 v[184:185], v[184:185], v[220:221] op_sel_hi:[1,0]
    v_pk_mul_f32 v[186:187], v[186:187], v[220:221] op_sel_hi:[1,0]
    v_pk_mul_f32 v[200:201], v[200:201], v[220:221] op_sel_hi:[1,0]
    v_pk_mul_f32 v[202:203], v[202:203], v[220:221] op_sel_hi:[1,0]
    v_cvt_pk_bf16_f32 v236, v184, v185
    v_cvt_pk_bf16_f32 v237, v186, v187
    v_cvt_pk_bf16_f32 v244, v200, v201
    v_cvt_pk_bf16_f32 v245, v202, v203
    v_pk_mul_f32 v[188:189], v[188:189], v[222:223] op_sel_hi:[1,0]
    v_pk_mul_f32 v[190:191], v[190:191], v[222:223] op_sel_hi:[1,0]
    v_pk_mul_f32 v[204:205], v[204:205], v[222:223] op_sel_hi:[1,0]
    v_pk_mul_f32 v[206:207], v[206:207], v[222:223] op_sel_hi:[1,0]
    v_cvt_pk_bf16_f32 v238, v188, v189
    v_cvt_pk_bf16_f32 v239, v190, v191
    v_cvt_pk_bf16_f32 v246, v204, v205
    v_cvt_pk_bf16_f32 v247, v206, v207
    v_cndmask_b32_e64 v240, v242, v240, s[40:41]
    v_cndmask_b32_e64 v241, v243, v241, s[40:41]
    buffer_store_dwordx4 v[232:235], v21, s[12:15], s60 offen sc1
    buffer_store_dwordx2 v[240:241], v25, s[12:15], s61 offen sc1
    v_cndmask_b32_e64 v244, v246, v244, s[40:41]
    v_cndmask_b32_e64 v245, v247, v245, s[40:41]
    buffer_store_dwordx4 v[236:239], v22, s[12:15], s60 offen sc1
    buffer_store_dwordx2 v[244:245], v26, s[12:15], s61 offen sc1
    s_cmp_eq_u32 s21, 0
    s_cbranch_scc1 K_HZ
    s_mov_b32 s50, 2097152
K_SPINH_19:
    ds_read_b32 v3, v2
    s_sub_u32 s50, s50, 1
    s_cmp_eq_u32 s50, 0
    s_cbranch_scc1 K_SPINDH_20
    s_waitcnt lgkmcnt(0)
    v_cmp_ne_u32 vcc, 1, v3
    s_nop 3
    s_cbranch_vccnz K_SPINH_19
K_SPINDH_20:
    s_waitcnt lgkmcnt(0)
    ds_read_b128 v[32:35], v28
    ds_read_b64 v[36:37], v29 offset:1024
    ds_read_b64 v[62:63], v29 offset:1536
    ds_read_b64 v[72:73], v29 offset:2048
    ds_read_b64 v[82:83], v29 offset:2560
    s_waitcnt lgkmcnt(0)
    s_branch K_HD
K_HZ:
    v_mov_b32 v32, 0
    v_mov_b32 v33, 0
    v_mov_b32 v34, 0
    v_mov_b32 v35, 0
    v_mov_b32 v36, 0
    v_mov_b32 v37, 0
    v_mov_b32 v62, 0
    v_mov_b32 v63, 0
    v_mov_b32 v72, 0
    v_mov_b32 v73, 0
    v_mov_b32 v82, 0
    v_mov_b32 v83, 0
K_HD:
    v_mfma_f32_16x16x32_bf16 v[128:131], v[50:53], v[116:119], v[12:15]
    v_mfma_f32_16x16x32_bf16 v[132:135], v[56:59], v[116:119], v[8:11]
    v_mfma_f32_16x16x32_bf16 v[136:139], v[52:55], v[120:123], v[12:15]
    v_mfma_f32_16x16x32_bf16 v[140:143], v[58:61], v[120:123], v[8:11]
    v_mfma_f32_16x16x32_bf16 v[144:147], v[32:35], v[92:95], v[16:19]
    v_mfma_f32_16x16x32_bf16 v[148:151], v[38:41], v[92:95], v[8:11]
    v_mfma_f32_16x16x32_bf16 v[152:155], v[34:37], v[96:99], v[16:19]
    v_mfma_f32_16x16x32_bf16 v[156:159], v[40:43], v[96:99], v[8:11]
    s_nop 0
    v_max3_f32 v208, v128, v129, v130
    s_nop 0
    v_max3_f32 v209, v136, v137, v138
    s_nop 0
    v_max3_f32 v210, v144, v145, v146
    s_nop 0
    v_max3_f32 v211, v152, v153, v154
    v_max3_f32 v208, v208, v131, v132
    v_max3_f32 v209, v209, v139, v140
    v_max3_f32 v210, v210, v147, v148
    v_max3_f32 v211, v211, v155, v156
    v_max3_f32 v208, v208, v133, v134
    v_max3_f32 v209, v209, v141, v142
    v_max3_f32 v210, v210, v149, v150
    v_max3_f32 v211, v211, v157, v158
    v_max_f32 v208, v208, v135
    v_max_f32 v209, v209, v143
    v_max_f32 v210, v210, v151
    v_max_f32 v211, v211, v159
    v_permlane32_swap_b32 v208, v209
    s_nop 0
    v_permlane32_swap_b32 v210, v211
    v_max_f32 v208, v208, v209
    v_max_f32 v210, v210, v211
    s_nop 1
    v_permlane16_swap_b32 v208, v210
    v_max_f32 v208, v208, v210
    v_mul_f32 v224, 0xbea52b5c, v208
    v_mov_b32 v226, v224
    s_nop 1
    v_permlane32_swap_b32 v224, v226
    v_mov_b32 v228, v224
    v_mov_b32 v230, v226
    s_nop 0
    v_permlane16_swap_b32 v224, v228
    v_permlane16_swap_b32 v226, v230
    v_pk_fma_f32 v[128:129], v[128:129], s[62:63], v[224:225] op_sel_hi:[1,1,0]
    v_pk_fma_f32 v[130:131], v[130:131], s[62:63], v[224:225] op_sel_hi:[1,1,0]
    v_pk_fma_f32 v[132:133], v[132:133], s[62:63], v[224:225] op_sel_hi:[1,1,0]
    v_pk_fma_f32 v[134:135], v[134:135], s[62:63], v[224:225] op_sel_hi:[1,1,0]
    v_pk_fma_f32 v[136:137], v[136:137], s[62:63], v[226:227] op_sel_hi:[1,1,0]
    v_pk_fma_f32 v[138:139], v[138:139], s[62:63], v[226:227] op_sel_hi:[1,1,0]
    v_pk_fma_f32 v[140:141], v[140:141], s[62:63], v[226:227] op_sel_hi:[1,1,0]
    v_pk_fma_f32 v[142:143], v[142:143], s[62:63], v[226:227] op_sel_hi:[1,1,0]
    v_pk_fma_f32 v[144:145], v[144:145], s[62:63], v[228:229] op_sel_hi:[1,1,0]
    v_pk_fma_f32 v[146:147], v[146:147], s[62:63], v[228:229] op_sel_hi:[1,1,0]
    v_pk_fma_f32 v[148:149], v[148:149], s[62:63], v[228:229] op_sel_hi:[1,1,0]
    v_pk_fma_f32 v[150:151], v[150:151], s[62:63], v[228:229] op_sel_hi:[1,1,0]
    v_pk_fma_f32 v[152:153], v[152:153], s[62:63], v[230:231] op_sel_hi:[1,1,0]
    v_pk_fma_f32 v[154:155], v[154:155], s[62:63], v[230:231] op_sel_hi:[1,1,0]
    v_pk_fma_f32 v[156:157], v[156:157], s[62:63], v[230:231] op_sel_hi:[1,1,0]
    v_pk_fma_f32 v[158:159], v[158:159], s[62:63], v[230:231] op_sel_hi:[1,1,0]
    v_exp_f32 v128, v128
    v_exp_f32 v129, v129
    v_exp_f32 v130, v130
    v_exp_f32 v131, v131
    v_exp_f32 v132, v132
    v_exp_f32 v133, v133
    v_exp_f32 v134, v134
    v_exp_f32 v135, v135
    v_exp_f32 v136, v136
    v_exp_f32 v137, v137
    v_exp_f32 v138, v138
    v_exp_f32 v139, v139
    v_exp_f32 v140, v140
    v_exp_f32 v141, v141
    v_exp_f32 v142, v142
    v_exp_f32 v143, v143
    v_cvt_pk_bf16_f32 v160, v128, v129
    v_cvt_pk_bf16_f32 v161, v130, v131
    v_cvt_pk_bf16_f32 v162, v132, v133
    v_cvt_pk_bf16_f32 v163, v134, v135
    v_exp_f32 v144, v144
    v_exp_f32 v145, v145
    v_exp_f32 v146, v146
    v_exp_f32 v147, v147
    v_exp_f32 v148, v148
    v_exp_f32 v149, v149
    v_exp_f32 v150, v150
    v_exp_f32 v151, v151
    v_cvt_pk_bf16_f32 v164, v136, v137
    v_cvt_pk_bf16_f32 v165, v138, v139
    v_cvt_pk_bf16_f32 v166, v140, v141
    v_cvt_pk_bf16_f32 v167, v142, v143
    v_exp_f32 v152, v152
    v_exp_f32 v153, v153
    v_exp_f32 v154, v154
    v_exp_f32 v155, v155
    v_exp_f32 v156, v156
    v_exp_f32 v157, v157
    v_exp_f32 v158, v158
    v_exp_f32 v159, v159
    v_cvt_pk_bf16_f32 v168, v144, v145
    v_cvt_pk_bf16_f32 v169, v146, v147
    v_cvt_pk_bf16_f32 v170, v148, v149
    v_cvt_pk_bf16_f32 v171, v150, v151
    v_cvt_pk_bf16_f32 v172, v152, v153
    v_cvt_pk_bf16_f32 v173, v154, v155
    v_cvt_pk_bf16_f32 v174, v156, v157
    v_cvt_pk_bf16_f32 v175, v158, v159
    v_mfma_f32_16x16x32_bf16 v[192:195], v[88:91], v[160:163], 0
    v_mfma_f32_16x16x32_bf16 v[176:179], v[68:71], v[160:163], 0
    v_mfma_f32_16x16x32_bf16 v[196:199], v[88:91], v[164:167], 0
    v_mfma_f32_16x16x32_bf16 v[180:183], v[78:81], v[164:167], 0
    v_mfma_f32_16x16x32_bf16 v[200:203], v[82:85], v[168:171], 0
    v_mfma_f32_16x16x32_bf16 v[184:187], v[62:65], v[168:171], 0
    v_mfma_f32_16x16x32_bf16 v[204:207], v[82:85], v[172:175], 0
    v_mfma_f32_16x16x32_bf16 v[188:191], v[72:75], v[172:175], 0
    s_nop 0
    v_mov_b32 v216, v192
    s_nop 0
    v_mov_b32 v218, v196
    s_nop 0
    v_mov_b32 v220, v200
    s_nop 0
    v_mov_b32 v222, v204
    v_permlane32_swap_b32 v193, v216
    v_permlane32_swap_b32 v197, v218
    v_permlane32_swap_b32 v201, v220
    v_permlane32_swap_b32 v205, v222
    v_rcp_f32 v216, v216
    v_rcp_f32 v218, v218
    v_rcp_f32 v220, v220
    v_rcp_f32 v222, v222
    v_pk_mul_f32 v[176:177], v[176:177], v[216:217] op_sel_hi:[1,0]
    v_pk_mul_f32 v[178:179], v[178:179], v[216:217] op_sel_hi:[1,0]
    v_pk_mul_f32 v[192:193], v[192:193], v[216:217] op_sel_hi:[1,0]
    v_pk_mul_f32 v[194:195], v[194:195], v[216:217] op_sel_hi:[1,0]
    v_cvt_pk_bf16_f32 v232, v176, v177
    v_cvt_pk_bf16_f32 v233, v178, v179
    v_cvt_pk_bf16_f32 v240, v192, v193
    v_cvt_pk_bf16_f32 v241, v194, v195
    v_pk_mul_f32 v[180:181], v[180:181], v[218:219] op_sel_hi:[1,0]
    v_pk_mul_f32 v[182:183], v[182:183], v[218:219] op_sel_hi:[1,0]
    v_pk_mul_f32 v[196:197], v[196:197], v[218:219] op_sel_hi:[1,0]
    v_pk_mul_f32 v[198:199], v[198:199], v[218:219] op_sel_hi:[1,0]
    v_cvt_pk_bf16_f32 v234, v180, v181
    v_cvt_pk_bf16_f32 v235, v182, v183
    v_cvt_pk_bf16_f32 v242, v196, v197
    v_cvt_pk_bf16_f32 v243, v198, v199
    v_pk_mul_f32 v[184:185], v[184:185], v[220:221] op_sel_hi:[1,0]
    v_pk_mul_f32 v[186:187], v[186:187], v[220:221] op_sel_hi:[1,0]
    v_pk_mul_f32 v[200:201], v[200:201], v[220:221] op_sel_hi:[1,0]
    v_pk_mul_f32 v[202:203], v[202:203], v[220:221] op_sel_hi:[1,0]
    v_cvt_pk_bf16_f32 v236, v184, v185
    v_cvt_pk_bf16_f32 v237, v186, v187
    v_cvt_pk_bf16_f32 v244, v200, v201
    v_cvt_pk_bf16_f32 v245, v202, v203
    v_pk_mul_f32 v[188:189], v[188:189], v[222:223] op_sel_hi:[1,0]
    v_pk_mul_f32 v[190:191], v[190:191], v[222:223] op_sel_hi:[1,0]
    v_pk_mul_f32 v[204:205], v[204:205], v[222:223] op_sel_hi:[1,0]
    v_pk_mul_f32 v[206:207], v[206:207], v[222:223] op_sel_hi:[1,0]
    v_cvt_pk_bf16_f32 v238, v188, v189
    v_cvt_pk_bf16_f32 v239, v190, v191
    v_cvt_pk_bf16_f32 v246, v204, v205
    v_cvt_pk_bf16_f32 v247, v206, v207
    v_cndmask_b32_e64 v240, v242, v240, s[40:41]
    v_cndmask_b32_e64 v241, v243, v241, s[40:41]
    buffer_store_dwordx4 v[232:235], v23, s[12:15], s60 offen sc1
    buffer_store_dwordx2 v[240:241], v27, s[12:15], s61 offen sc1
    v_cndmask_b32_e64 v244, v246, v244, s[40:41]
    v_cndmask_b32_e64 v245, v247, v245, s[40:41]
    buffer_store_dwordx4 v[236:239], v20, s[12:15], s60 offen sc1
    buffer_store_dwordx2 v[244:245], v24, s[12:15], s61 offen sc1
    s_branch K_ARRIVE
K_HBODY:
    s_waitcnt lgkmcnt(0)
    s_mov_b32 s12, s42
    s_mov_b32 s13, s43
    s_mov_b32 s14, 13762560
    s_mov_b32 s15, 0x20000
    s_mov_b32 s96, s40
    s_mov_b32 s97, s41
    s_mov_b32 s98, 256
    s_mov_b32 s99, 0x20000
    s_lshl_b32 s48, s2, 2
    s_add_u32 s48, s48, s20
    s_cmp_lg_u32 s48, 1
    s_cbranch_scc1 K_NOCLRH
    v_lshlrev_b32 v104, 7, v1
    v_add_u32 v104, 13697024, v104
    v_mov_b32 v108, 0
    v_mov_b32 v109, 0
    v_mov_b32 v110, 0
    v_mov_b32 v111, 0
    buffer_store_dwordx4 v[108:111], v104, s[12:15], 0 offen sc1
    v_add_u32 v104, 8192, v104
    buffer_store_dwordx4 v[108:111], v104, s[12:15], 0 offen sc1
    v_add_u32 v104, 8192, v104
    buffer_store_dwordx4 v[108:111], v104, s[12:15], 0 offen sc1
    v_add_u32 v104, 8192, v104
    buffer_store_dwordx4 v[108:111], v104, s[12:15], 0 offen sc1
    v_mov_b32 v104, 0
    v_mov_b32 v105, 1
    s_waitcnt vmcnt(0)
    s_mov_b64 exec, 1
    buffer_store_dword v105, v104, s[96:99], 0 offen sc1
    s_mov_b64 exec, -1
K_NOCLRH:
    v_lshrrev_b32 v104, 4, v1
    v_lshlrev_b32 v104, 3, v104
    s_lshl_b32 s48, s25, 9
    s_lshl_b32 s49, s22, 8
    s_add_u32 s48, s48, s49
    v_add_u32 v104, s48, v104
    s_mov_b32 s40, s38
    s_mov_b32 s41, s39
    s_mov_b32 s42, 3456
    s_mov_b32 s43, 0x20000
    buffer_load_dwordx2 v[80:81], v104, s[40:43], 0 offen offset:0
    buffer_load_dwordx2 v[82:83], v104, s[40:43], 0 offen offset:32
    buffer_load_dwordx2 v[84:85], v104, s[40:43], 0 offen offset:64
    buffer_load_dwordx2 v[86:87], v104, s[40:43], 0 offen offset:96
    buffer_load_dwordx2 v[88:89], v104, s[40:43], 0 offen offset:128
    buffer_load_dwordx2 v[90:91], v104, s[40:43], 0 offen offset:160
    buffer_load_dwordx2 v[92:93], v104, s[40:43], 0 offen offset:192
    buffer_load_dwordx2 v[94:95], v104, s[40:43], 0 offen offset:224
    v_lshrrev_b32 v104, 5, v1
    v_lshrrev_b32 v105, 2, v1
    v_and_b32 v105, 7, v105
    v_lshlrev_b32 v104, 10, v104
    v_lshl_add_u32 v104, v105, 7, v104
    v_and_b32 v108, 3, v1
    v_lshl_add_u32 v104, v108, 3, v104
    s_lshl_b32 s48, s22, 14
    s_add_u32 s48, s48, 16384
    v_add_u32 v104, s48, v104
    v_lshrrev_b32 v105, 1, v105
    v_xor_b32 v108, 0, v105
    v_lshl_add_u32 v4, v108, 5, v104
    v_xor_b32 v108, 1, v105
    v_lshl_add_u32 v5, v108, 5, v104
    v_xor_b32 v108, 2, v105
    v_lshl_add_u32 v6, v108, 5, v104
    v_xor_b32 v108, 3, v105
    v_lshl_add_u32 v7, v108, 5, v104
    s_waitcnt vmcnt(0)
    v_lshlrev_b32 v32, 16, v80
    v_and_b32 v33, 0xffff0000, v80
    v_lshlrev_b32 v34, 16, v81
    v_and_b32 v35, 0xffff0000, v81
    v_lshlrev_b32 v36, 16, v82
    v_and_b32 v37, 0xffff0000, v82
    v_lshlrev_b32 v38, 16, v83
    v_and_b32 v39, 0xffff0000, v83
    v_lshlrev_b32 v40, 16, v84
    v_and_b32 v41, 0xffff0000, v84
    v_lshlrev_b32 v42, 16, v85
    v_and_b32 v43, 0xffff0000, v85
    v_lshlrev_b32 v44, 16, v86
    v_and_b32 v45, 0xffff0000, v86
    v_lshlrev_b32 v46, 16, v87
    v_and_b32 v47, 0xffff0000, v87
    v_lshlrev_b32 v48, 16, v88
    v_and_b32 v49, 0xffff0000, v88
    v_lshlrev_b32 v50, 16, v89
    v_and_b32 v51, 0xffff0000, v89
    v_lshlrev_b32 v52, 16, v90
    v_and_b32 v53, 0xffff0000, v90
    v_lshlrev_b32 v54, 16, v91
    v_and_b32 v55, 0xffff0000, v91
    v_lshlrev_b32 v56, 16, v92
    v_and_b32 v57, 0xffff0000, v92
    v_lshlrev_b32 v58, 16, v93
    v_and_b32 v59, 0xffff0000, v93
    v_lshlrev_b32 v60, 16, v94
    v_and_b32 v61, 0xffff0000, v94
    v_lshlrev_b32 v62, 16, v95
    v_and_b32 v63, 0xffff0000, v95
    v_mov_b32 v128, v32
    v_mov_b32 v129, v33
    v_mov_b32 v130, v34
    v_mov_b32 v131, v35
    v_mov_b32 v132, v36
    v_mov_b32 v133, v37
    v_mov_b32 v134, v38
    v_mov_b32 v135, v39
    v_mov_b32 v136, v40
    v_mov_b32 v137, v41
    v_mov_b32 v138, v42
    v_mov_b32 v139, v43
    v_mov_b32 v140, v44
    v_mov_b32 v141, v45
    v_mov_b32 v142, v46
    v_mov_b32 v143, v47
    v_mov_b32 v144, v48
    v_mov_b32 v145, v49
    v_mov_b32 v146, v50
    v_mov_b32 v147, v51
    v_mov_b32 v148, v52
    v_mov_b32 v149, v53
    v_mov_b32 v150, v54
    v_mov_b32 v151, v55
    v_mov_b32 v152, v56
    v_mov_b32 v153, v57
    v_mov_b32 v154, v58
    v_mov_b32 v155, v59
    v_mov_b32 v156, v60
    v_mov_b32 v157, v61
    v_mov_b32 v158, v62
    v_mov_b32 v159, v63
    v_mov_b32 v160, v32
    v_mov_b32 v161, v33
    v_mov_b32 v162, v34
    v_mov_b32 v163, v35
    v_mov_b32 v164, v36
    v_mov_b32 v165, v37
    v_mov_b32 v166, v38
    v_mov_b32 v167, v39
    v_mov_b32 v168, v40
    v_mov_b32 v169, v41
    v_mov_b32 v170, v42
    v_mov_b32 v171, v43
    v_mov_b32 v172, v44
    v_mov_b32 v173, v45
    v_mov_b32 v174, v46
    v_mov_b32 v175, v47
    v_mov_b32 v176, v48
    v_mov_b32 v177, v49
    v_mov_b32 v178, v50
    v_mov_b32 v179, v51
    v_mov_b32 v180, v52
    v_mov_b32 v181, v53
    v_mov_b32 v182, v54
    v_mov_b32 v183, v55
    v_mov_b32 v184, v56
    v_mov_b32 v185, v57
    v_mov_b32 v186, v58
    v_mov_b32 v187, v59
    v_mov_b32 v188, v60
    v_mov_b32 v189, v61
    v_mov_b32 v190, v62
    v_mov_b32 v191, v63
    v_mov_b32 v192, v32
    v_mov_b32 v193, v33
    v_mov_b32 v194, v34
    v_mov_b32 v195, v35
    v_mov_b32 v196, v36
    v_mov_b32 v197, v37
    v_mov_b32 v198, v38
    v_mov_b32 v199, v39
    v_mov_b32 v200, v40
    v_mov_b32 v201, v41
    v_mov_b32 v202, v42
    v_mov_b32 v203, v43
    v_mov_b32 v204, v44
    v_mov_b32 v205, v45
    v_mov_b32 v206, v46
    v_mov_b32 v207, v47
    v_mov_b32 v208, v48
    v_mov_b32 v209, v49
    v_mov_b32 v210, v50
    v_mov_b32 v211, v51
    v_mov_b32 v212, v52
    v_mov_b32 v213, v53
    v_mov_b32 v214, v54
    v_mov_b32 v215, v55
    v_mov_b32 v216, v56
    v_mov_b32 v217, v57
    v_mov_b32 v218, v58
    v_mov_b32 v219, v59
    v_mov_b32 v220, v60
    v_mov_b32 v221, v61
    v_mov_b32 v222, v62
    v_mov_b32 v223, v63
    v_mov_b32 v224, v32
    v_mov_b32 v225, v33
    v_mov_b32 v226, v34
    v_mov_b32 v227, v35
    v_mov_b32 v228, v36
    v_mov_b32 v229, v37
    v_mov_b32 v230, v38
    v_mov_b32 v231, v39
    v_mov_b32 v232, v40
    v_mov_b32 v233, v41
    v_mov_b32 v234, v42
    v_mov_b32 v235, v43
    v_mov_b32 v236, v44
    v_mov_b32 v237, v45
    v_mov_b32 v238, v46
    v_mov_b32 v239, v47
    v_mov_b32 v240, v48
    v_mov_b32 v241, v49
    v_mov_b32 v242, v50
    v_mov_b32 v243, v51
    v_mov_b32 v244, v52
    v_mov_b32 v245, v53
    v_mov_b32 v246, v54
    v_mov_b32 v247, v55
    v_mov_b32 v248, v56
    v_mov_b32 v249, v57
    v_mov_b32 v250, v58
    v_mov_b32 v251, v59
    v_mov_b32 v252, v60
    v_mov_b32 v253, v61
    v_mov_b32 v254, v62
    v_mov_b32 v255, v63
    s_mov_b32 s28, 0
    s_mov_b32 s50, 9
    s_mov_b32 s30, 4
    s_barrier
    ds_read_b64_tr_b16 v[48:49], v4 offset:0
    ds_read_b64_tr_b16 v[50:51], v4 offset:2048
    ds_read_b128 v[32:35], v2 offset:0
    ds_read_b128 v[36:39], v2 offset:2048
    ds_read_b128 v[40:43], v2 offset:4096
    ds_read_b128 v[44:47], v2 offset:6144
    ds_read_b64_tr_b16 v[52:53], v5 offset:0
    ds_read_b64_tr_b16 v[54:55], v5 offset:2048
    ds_read_b64_tr_b16 v[56:57], v6 offset:0
    ds_read_b64_tr_b16 v[58:59], v6 offset:2048
    ds_read_b64_tr_b16 v[60:61], v7 offset:0
    ds_read_b64_tr_b16 v[62:63], v7 offset:2048
    ds_read_b64_tr_b16 v[64:65], v4 offset:8192
    ds_read_b64_tr_b16 v[66:67], v4 offset:10240
    ds_read_b64_tr_b16 v[68:69], v5 offset:8192
    ds_read_b64_tr_b16 v[70:71], v5 offset:10240
    ds_read_b64_tr_b16 v[72:73], v6 offset:8192
    ds_read_b64_tr_b16 v[74:75], v6 offset:10240
    ds_read_b64_tr_b16 v[76:77], v7 offset:8192
    ds_read_b64_tr_b16 v[78:79], v7 offset:10240
    s_waitcnt lgkmcnt(0)
.p2align 3
K_LOOPH:
    s_add_u32 s49, s28, 49152
    s_cmp_eq_u32 s49, 147456
    s_cselect_b32 s49, 0, s49
    s_sub_u32 s29, s49, s28
    s_mov_b32 s28, s49
    v_mfma_f32_16x16x32_bf16 v[128:131], v[48:51], v[32:35], v[128:131]
    ds_read_b64_tr_b16 v[96:97], v4 offset:4096
    v_mfma_f32_16x16x32_bf16 v[160:163], v[48:51], v[36:39], v[160:163]
    ds_read_b64_tr_b16 v[98:99], v4 offset:6144
    v_mfma_f32_16x16x32_bf16 v[192:195], v[48:51], v[40:43], v[192:195]
    ds_read_b128 v[80:83], v3 offset:0
    v_mfma_f32_16x16x32_bf16 v[224:227], v[48:51], v[44:47], v[224:227]
    ds_read_b128 v[84:87], v3 offset:2048
    v_mfma_f32_16x16x32_bf16 v[132:135], v[52:55], v[32:35], v[132:135]
    ds_read_b128 v[88:91], v3 offset:4096
    v_mfma_f32_16x16x32_bf16 v[164:167], v[52:55], v[36:39], v[164:167]
    ds_read_b128 v[92:95], v3 offset:6144
    v_mfma_f32_16x16x32_bf16 v[196:199], v[52:55], v[40:43], v[196:199]
    ds_read_b64_tr_b16 v[100:101], v5 offset:4096
    v_mfma_f32_16x16x32_bf16 v[228:231], v[52:55], v[44:47], v[228:231]
    ds_read_b64_tr_b16 v[102:103], v5 offset:6144
    v_mfma_f32_16x16x32_bf16 v[136:139], v[56:59], v[32:35], v[136:139]
    ds_read_b64_tr_b16 v[104:105], v6 offset:4096
    v_mfma_f32_16x16x32_bf16 v[168:171], v[56:59], v[36:39], v[168:171]
    ds_read_b64_tr_b16 v[106:107], v6 offset:6144
    v_mfma_f32_16x16x32_bf16 v[200:203], v[56:59], v[40:43], v[200:203]
    ds_read_b64_tr_b16 v[108:109], v7 offset:4096
    v_mfma_f32_16x16x32_bf16 v[232:235], v[56:59], v[44:47], v[232:235]
    ds_read_b64_tr_b16 v[110:111], v7 offset:6144
    v_mfma_f32_16x16x32_bf16 v[140:143], v[60:63], v[32:35], v[140:143]
    ds_read_b64_tr_b16 v[112:113], v4 offset:12288
    v_mfma_f32_16x16x32_bf16 v[172:175], v[60:63], v[36:39], v[172:175]
    ds_read_b64_tr_b16 v[114:115], v4 offset:14336
    v_mfma_f32_16x16x32_bf16 v[204:207], v[60:63], v[40:43], v[204:207]
    ds_read_b64_tr_b16 v[116:117], v5 offset:12288
    v_mfma_f32_16x16x32_bf16 v[236:239], v[60:63], v[44:47], v[236:239]
    ds_read_b64_tr_b16 v[118:119], v5 offset:14336
    v_mfma_f32_16x16x32_bf16 v[144:147], v[64:67], v[32:35], v[144:147]
    ds_read_b64_tr_b16 v[120:121], v6 offset:12288
    v_mfma_f32_16x16x32_bf16 v[176:179], v[64:67], v[36:39], v[176:179]
    ds_read_b64_tr_b16 v[122:123], v6 offset:14336
    v_mfma_f32_16x16x32_bf16 v[208:211], v[64:67], v[40:43], v[208:211]
    ds_read_b64_tr_b16 v[124:125], v7 offset:12288
    v_mfma_f32_16x16x32_bf16 v[240:243], v[64:67], v[44:47], v[240:243]
    ds_read_b64_tr_b16 v[126:127], v7 offset:14336
    v_mfma_f32_16x16x32_bf16 v[148:151], v[68:71], v[32:35], v[148:151]
    v_add_u32 v2, s29, v2
    v_add_u32 v3, s29, v3
    v_add_u32 v4, s29, v4
    v_add_u32 v5, s29, v5
    v_add_u32 v6, s29, v6
    v_add_u32 v7, s29, v7
    v_mfma_f32_16x16x32_bf16 v[180:183], v[68:71], v[36:39], v[180:183]
    v_mfma_f32_16x16x32_bf16 v[212:215], v[68:71], v[40:43], v[212:215]
    v_mfma_f32_16x16x32_bf16 v[244:247], v[68:71], v[44:47], v[244:247]
    v_mfma_f32_16x16x32_bf16 v[152:155], v[72:75], v[32:35], v[152:155]
    v_mfma_f32_16x16x32_bf16 v[184:187], v[72:75], v[36:39], v[184:187]
    v_mfma_f32_16x16x32_bf16 v[216:219], v[72:75], v[40:43], v[216:219]
    v_mfma_f32_16x16x32_bf16 v[248:251], v[72:75], v[44:47], v[248:251]
    v_mfma_f32_16x16x32_bf16 v[156:159], v[76:79], v[32:35], v[156:159]
    v_mfma_f32_16x16x32_bf16 v[188:191], v[76:79], v[36:39], v[188:191]
    v_mfma_f32_16x16x32_bf16 v[220:223], v[76:79], v[40:43], v[220:223]
    v_mfma_f32_16x16x32_bf16 v[252:255], v[76:79], v[44:47], v[252:255]
    s_waitcnt lgkmcnt(0)
    s_barrier
    v_mfma_f32_16x16x32_bf16 v[128:131], v[96:99], v[80:83], v[128:131]
    ds_read_b64_tr_b16 v[48:49], v4 offset:0
    v_mfma_f32_16x16x32_bf16 v[160:163], v[96:99], v[84:87], v[160:163]
    ds_read_b64_tr_b16 v[50:51], v4 offset:2048
    v_mfma_f32_16x16x32_bf16 v[192:195], v[96:99], v[88:91], v[192:195]
    ds_read_b128 v[32:35], v2 offset:0
    v_mfma_f32_16x16x32_bf16 v[224:227], v[96:99], v[92:95], v[224:227]
    ds_read_b128 v[36:39], v2 offset:2048
    v_mfma_f32_16x16x32_bf16 v[132:135], v[100:103], v[80:83], v[132:135]
    ds_read_b128 v[40:43], v2 offset:4096
    v_mfma_f32_16x16x32_bf16 v[164:167], v[100:103], v[84:87], v[164:167]
    ds_read_b128 v[44:47], v2 offset:6144
    v_mfma_f32_16x16x32_bf16 v[196:199], v[100:103], v[88:91], v[196:199]
    ds_read_b64_tr_b16 v[52:53], v5 offset:0
    v_mfma_f32_16x16x32_bf16 v[228:231], v[100:103], v[92:95], v[228:231]
    ds_read_b64_tr_b16 v[54:55], v5 offset:2048
    v_mfma_f32_16x16x32_bf16 v[136:139], v[104:107], v[80:83], v[136:139]
    ds_read_b64_tr_b16 v[56:57], v6 offset:0
    v_mfma_f32_16x16x32_bf16 v[168:171], v[104:107], v[84:87], v[168:171]
    ds_read_b64_tr_b16 v[58:59], v6 offset:2048
    v_mfma_f32_16x16x32_bf16 v[200:203], v[104:107], v[88:91], v[200:203]
    ds_read_b64_tr_b16 v[60:61], v7 offset:0
    v_mfma_f32_16x16x32_bf16 v[232:235], v[104:107], v[92:95], v[232:235]
    ds_read_b64_tr_b16 v[62:63], v7 offset:2048
    v_mfma_f32_16x16x32_bf16 v[140:143], v[108:111], v[80:83], v[140:143]
    ds_read_b64_tr_b16 v[64:65], v4 offset:8192
    v_mfma_f32_16x16x32_bf16 v[172:175], v[108:111], v[84:87], v[172:175]
    ds_read_b64_tr_b16 v[66:67], v4 offset:10240
    v_mfma_f32_16x16x32_bf16 v[204:207], v[108:111], v[88:91], v[204:207]
    ds_read_b64_tr_b16 v[68:69], v5 offset:8192
    v_mfma_f32_16x16x32_bf16 v[236:239], v[108:111], v[92:95], v[236:239]
    ds_read_b64_tr_b16 v[70:71], v5 offset:10240
    v_mfma_f32_16x16x32_bf16 v[144:147], v[112:115], v[80:83], v[144:147]
    ds_read_b64_tr_b16 v[72:73], v6 offset:8192
    v_mfma_f32_16x16x32_bf16 v[176:179], v[112:115], v[84:87], v[176:179]
    ds_read_b64_tr_b16 v[74:75], v6 offset:10240
    v_mfma_f32_16x16x32_bf16 v[208:211], v[112:115], v[88:91], v[208:211]
    ds_read_b64_tr_b16 v[76:77], v7 offset:8192
    v_mfma_f32_16x16x32_bf16 v[240:243], v[112:115], v[92:95], v[240:243]
    ds_read_b64_tr_b16 v[78:79], v7 offset:10240
    v_mfma_f32_16x16x32_bf16 v[148:151], v[116:119], v[80:83], v[148:151]
    v_mfma_f32_16x16x32_bf16 v[180:183], v[116:119], v[84:87], v[180:183]
    v_mfma_f32_16x16x32_bf16 v[212:215], v[116:119], v[88:91], v[212:215]
    v_mfma_f32_16x16x32_bf16 v[244:247], v[116:119], v[92:95], v[244:247]
    v_mfma_f32_16x16x32_bf16 v[152:155], v[120:123], v[80:83], v[152:155]
    v_mfma_f32_16x16x32_bf16 v[184:187], v[120:123], v[84:87], v[184:187]
    v_mfma_f32_16x16x32_bf16 v[216:219], v[120:123], v[88:91], v[216:219]
    v_mfma_f32_16x16x32_bf16 v[248:251], v[120:123], v[92:95], v[248:251]
    v_mfma_f32_16x16x32_bf16 v[156:159], v[124:127], v[80:83], v[156:159]
    v_mfma_f32_16x16x32_bf16 v[188:191], v[124:127], v[84:87], v[188:191]
    v_mfma_f32_16x16x32_bf16 v[220:223], v[124:127], v[88:91], v[220:223]
    v_mfma_f32_16x16x32_bf16 v[252:255], v[124:127], v[92:95], v[252:255]
    s_waitcnt lgkmcnt(0)
    s_sub_u32 s50, s50, 1
    s_cmp_lg_u32 s50, 0
    s_cbranch_scc1 K_LOOPH
    v_mfma_f32_16x16x32_bf16 v[128:131], v[48:51], v[32:35], v[128:131]
    ds_read_b64_tr_b16 v[96:97], v4 offset:4096
    v_mfma_f32_16x16x32_bf16 v[160:163], v[48:51], v[36:39], v[160:163]
    ds_read_b64_tr_b16 v[98:99], v4 offset:6144
    v_mfma_f32_16x16x32_bf16 v[192:195], v[48:51], v[40:43], v[192:195]
    ds_read_b128 v[80:83], v3 offset:0
    v_mfma_f32_16x16x32_bf16 v[224:227], v[48:51], v[44:47], v[224:227]
    ds_read_b128 v[84:87], v3 offset:2048
    v_mfma_f32_16x16x32_bf16 v[132:135], v[52:55], v[32:35], v[132:135]
    ds_read_b128 v[88:91], v3 offset:4096
    v_mfma_f32_16x16x32_bf16 v[164:167], v[52:55], v[36:39], v[164:167]
    ds_read_b128 v[92:95], v3 offset:6144
    v_mfma_f32_16x16x32_bf16 v[196:199], v[52:55], v[40:43], v[196:199]
    ds_read_b64_tr_b16 v[100:101], v5 offset:4096
    v_mfma_f32_16x16x32_bf16 v[228:231], v[52:55], v[44:47], v[228:231]
    ds_read_b64_tr_b16 v[102:103], v5 offset:6144
    v_mfma_f32_16x16x32_bf16 v[136:139], v[56:59], v[32:35], v[136:139]
    ds_read_b64_tr_b16 v[104:105], v6 offset:4096
    v_mfma_f32_16x16x32_bf16 v[168:171], v[56:59], v[36:39], v[168:171]
    ds_read_b64_tr_b16 v[106:107], v6 offset:6144
    v_mfma_f32_16x16x32_bf16 v[200:203], v[56:59], v[40:43], v[200:203]
    ds_read_b64_tr_b16 v[108:109], v7 offset:4096
    v_mfma_f32_16x16x32_bf16 v[232:235], v[56:59], v[44:47], v[232:235]
    ds_read_b64_tr_b16 v[110:111], v7 offset:6144
    v_mfma_f32_16x16x32_bf16 v[140:143], v[60:63], v[32:35], v[140:143]
    ds_read_b64_tr_b16 v[112:113], v4 offset:12288
    v_mfma_f32_16x16x32_bf16 v[172:175], v[60:63], v[36:39], v[172:175]
    ds_read_b64_tr_b16 v[114:115], v4 offset:14336
    v_mfma_f32_16x16x32_bf16 v[204:207], v[60:63], v[40:43], v[204:207]
    ds_read_b64_tr_b16 v[116:117], v5 offset:12288
    v_mfma_f32_16x16x32_bf16 v[236:239], v[60:63], v[44:47], v[236:239]
    ds_read_b64_tr_b16 v[118:119], v5 offset:14336
    v_mfma_f32_16x16x32_bf16 v[144:147], v[64:67], v[32:35], v[144:147]
    ds_read_b64_tr_b16 v[120:121], v6 offset:12288
    v_mfma_f32_16x16x32_bf16 v[176:179], v[64:67], v[36:39], v[176:179]
    ds_read_b64_tr_b16 v[122:123], v6 offset:14336
    v_mfma_f32_16x16x32_bf16 v[208:211], v[64:67], v[40:43], v[208:211]
    ds_read_b64_tr_b16 v[124:125], v7 offset:12288
    v_mfma_f32_16x16x32_bf16 v[240:243], v[64:67], v[44:47], v[240:243]
    ds_read_b64_tr_b16 v[126:127], v7 offset:14336
    v_mfma_f32_16x16x32_bf16 v[148:151], v[68:71], v[32:35], v[148:151]
    v_mfma_f32_16x16x32_bf16 v[180:183], v[68:71], v[36:39], v[180:183]
    v_mfma_f32_16x16x32_bf16 v[212:215], v[68:71], v[40:43], v[212:215]
    v_mfma_f32_16x16x32_bf16 v[244:247], v[68:71], v[44:47], v[244:247]
    v_mfma_f32_16x16x32_bf16 v[152:155], v[72:75], v[32:35], v[152:155]
    v_mfma_f32_16x16x32_bf16 v[184:187], v[72:75], v[36:39], v[184:187]
    v_mfma_f32_16x16x32_bf16 v[216:219], v[72:75], v[40:43], v[216:219]
    v_mfma_f32_16x16x32_bf16 v[248:251], v[72:75], v[44:47], v[248:251]
    v_mfma_f32_16x16x32_bf16 v[156:159], v[76:79], v[32:35], v[156:159]
    v_mfma_f32_16x16x32_bf16 v[188:191], v[76:79], v[36:39], v[188:191]
    v_mfma_f32_16x16x32_bf16 v[220:223], v[76:79], v[40:43], v[220:223]
    v_mfma_f32_16x16x32_bf16 v[252:255], v[76:79], v[44:47], v[252:255]
    s_waitcnt lgkmcnt(0)
    v_mov_b32 v32, 147480
    v_mov_b32 v33, 1
    s_mov_b64 exec, 1
    ds_add_u32 v32, v33
    s_mov_b64 exec, -1
    v_mfma_f32_16x16x32_bf16 v[128:131], v[96:99], v[80:83], v[128:131]
    v_mfma_f32_16x16x32_bf16 v[160:163], v[96:99], v[84:87], v[160:163]
    v_mfma_f32_16x16x32_bf16 v[192:195], v[96:99], v[88:91], v[192:195]
    v_mfma_f32_16x16x32_bf16 v[224:227], v[96:99], v[92:95], v[224:227]
    v_mfma_f32_16x16x32_bf16 v[132:135], v[100:103], v[80:83], v[132:135]
    v_mfma_f32_16x16x32_bf16 v[164:167], v[100:103], v[84:87], v[164:167]
    v_mfma_f32_16x16x32_bf16 v[196:199], v[100:103], v[88:91], v[196:199]
    v_mfma_f32_16x16x32_bf16 v[228:231], v[100:103], v[92:95], v[228:231]
    v_mfma_f32_16x16x32_bf16 v[136:139], v[104:107], v[80:83], v[136:139]
    v_mfma_f32_16x16x32_bf16 v[168:171], v[104:107], v[84:87], v[168:171]
    v_mfma_f32_16x16x32_bf16 v[200:203], v[104:107], v[88:91], v[200:203]
    v_mfma_f32_16x16x32_bf16 v[232:235], v[104:107], v[92:95], v[232:235]
    v_mfma_f32_16x16x32_bf16 v[140:143], v[108:111], v[80:83], v[140:143]
    v_mfma_f32_16x16x32_bf16 v[172:175], v[108:111], v[84:87], v[172:175]
    v_mfma_f32_16x16x32_bf16 v[204:207], v[108:111], v[88:91], v[204:207]
    v_mfma_f32_16x16x32_bf16 v[236:239], v[108:111], v[92:95], v[236:239]
    v_mfma_f32_16x16x32_bf16 v[144:147], v[112:115], v[80:83], v[144:147]
    v_mfma_f32_16x16x32_bf16 v[176:179], v[112:115], v[84:87], v[176:179]
    v_mfma_f32_16x16x32_bf16 v[208:211], v[112:115], v[88:91], v[208:211]
    v_mfma_f32_16x16x32_bf16 v[240:243], v[112:115], v[92:95], v[240:243]
    v_mfma_f32_16x16x32_bf16 v[148:151], v[116:119], v[80:83], v[148:151]
    v_mfma_f32_16x16x32_bf16 v[180:183], v[116:119], v[84:87], v[180:183]
    v_mfma_f32_16x16x32_bf16 v[212:215], v[116:119], v[88:91], v[212:215]
    v_mfma_f32_16x16x32_bf16 v[244:247], v[116:119], v[92:95], v[244:247]
    v_mfma_f32_16x16x32_bf16 v[152:155], v[120:123], v[80:83], v[152:155]
    v_mfma_f32_16x16x32_bf16 v[184:187], v[120:123], v[84:87], v[184:187]
    v_mfma_f32_16x16x32_bf16 v[216:219], v[120:123], v[88:91], v[216:219]
    v_mfma_f32_16x16x32_bf16 v[248:251], v[120:123], v[92:95], v[248:251]
    v_mfma_f32_16x16x32_bf16 v[156:159], v[124:127], v[80:83], v[156:159]
    v_mfma_f32_16x16x32_bf16 v[188:191], v[124:127], v[84:87], v[188:191]
    v_mfma_f32_16x16x32_bf16 v[220:223], v[124:127], v[88:91], v[220:223]
    v_mfma_f32_16x16x32_bf16 v[252:255], v[124:127], v[92:95], v[252:255]
    s_mov_b32 s62, 0xbdd2d3e8
    s_mov_b32 s63, 0xbdd2d3e8
    v_mov_b32 v2, 0xc0135761
    v_mov_b32 v3, 0xc0135761
    v_lshlrev_b32 v4, 4, v1
    s_lshl_b32 s48, s24, 1
    s_add_u32 s48, s48, s21
    s_mul_i32 s48, s48, 74
    s_lshl_b32 s49, s25, 3
    s_add_u32 s48, s48, s49
    s_lshl_b32 s49, s22, 2
    s_add_u32 s48, s48, s49
    s_lshl_b32 s60, s48, 12
    s_nop 7
    v_pk_mul_f32 v[8:9], v[128:129], v[128:129]
    v_pk_mul_f32 v[10:11], v[130:131], v[130:131]
    v_pk_mul_f32 v[12:13], v[132:133], v[132:133]
    v_pk_mul_f32 v[14:15], v[134:135], v[134:135]
    v_pk_fma_f32 v[8:9], v[8:9], s[62:63], v[2:3]
    v_pk_fma_f32 v[10:11], v[10:11], s[62:63], v[2:3]
    v_pk_fma_f32 v[12:13], v[12:13], s[62:63], v[2:3]
    v_pk_fma_f32 v[14:15], v[14:15], s[62:63], v[2:3]
    v_pk_mul_f32 v[8:9], v[8:9], v[128:129]
    v_pk_mul_f32 v[10:11], v[10:11], v[130:131]
    v_pk_mul_f32 v[12:13], v[12:13], v[132:133]
    v_pk_mul_f32 v[14:15], v[14:15], v[134:135]
    v_exp_f32 v8, v8
    v_exp_f32 v9, v9
    v_exp_f32 v10, v10
    v_exp_f32 v11, v11
    v_exp_f32 v12, v12
    v_exp_f32 v13, v13
    v_exp_f32 v14, v14
    v_exp_f32 v15, v15
    v_pk_add_f32 v[8:9], v[8:9], 1.0 op_sel_hi:[1,0]
    v_pk_add_f32 v[10:11], v[10:11], 1.0 op_sel_hi:[1,0]
    v_pk_add_f32 v[12:13], v[12:13], 1.0 op_sel_hi:[1,0]
    v_pk_add_f32 v[14:15], v[14:15], 1.0 op_sel_hi:[1,0]
    v_rcp_f32 v8, v8
    v_rcp_f32 v9, v9
    v_rcp_f32 v10, v10
    v_rcp_f32 v11, v11
    v_rcp_f32 v12, v12
    v_rcp_f32 v13, v13
    v_rcp_f32 v14, v14
    v_rcp_f32 v15, v15
    v_pk_mul_f32 v[8:9], v[8:9], v[128:129]
    v_pk_mul_f32 v[10:11], v[10:11], v[130:131]
    v_pk_mul_f32 v[12:13], v[12:13], v[132:133]
    v_pk_mul_f32 v[14:15], v[14:15], v[134:135]
    v_cvt_pk_bf16_f32 v32, v8, v9
    v_cvt_pk_bf16_f32 v33, v10, v11
    v_cvt_pk_bf16_f32 v34, v12, v13
    v_cvt_pk_bf16_f32 v35, v14, v15
    buffer_store_dwordx4 v[32:35], v4, s[12:15], s60 offen sc1
    v_pk_mul_f32 v[16:17], v[160:161], v[160:161]
    v_pk_mul_f32 v[18:19], v[162:163], v[162:163]
    v_pk_mul_f32 v[20:21], v[164:165], v[164:165]
    v_pk_mul_f32 v[22:23], v[166:167], v[166:167]
    v_pk_fma_f32 v[16:17], v[16:17], s[62:63], v[2:3]
    v_pk_fma_f32 v[18:19], v[18:19], s[62:63], v[2:3]
    v_pk_fma_f32 v[20:21], v[20:21], s[62:63], v[2:3]
    v_pk_fma_f32 v[22:23], v[22:23], s[62:63], v[2:3]
    v_pk_mul_f32 v[16:17], v[16:17], v[160:161]
    v_pk_mul_f32 v[18:19], v[18:19], v[162:163]
    v_pk_mul_f32 v[20:21], v[20:21], v[164:165]
    v_pk_mul_f32 v[22:23], v[22:23], v[166:167]
    v_exp_f32 v16, v16
    v_exp_f32 v17, v17
    v_exp_f32 v18, v18
    v_exp_f32 v19, v19
    v_exp_f32 v20, v20
    v_exp_f32 v21, v21
    v_exp_f32 v22, v22
    v_exp_f32 v23, v23
    v_pk_add_f32 v[16:17], v[16:17], 1.0 op_sel_hi:[1,0]
    v_pk_add_f32 v[18:19], v[18:19], 1.0 op_sel_hi:[1,0]
    v_pk_add_f32 v[20:21], v[20:21], 1.0 op_sel_hi:[1,0]
    v_pk_add_f32 v[22:23], v[22:23], 1.0 op_sel_hi:[1,0]
    v_rcp_f32 v16, v16
    v_rcp_f32 v17, v17
    v_rcp_f32 v18, v18
    v_rcp_f32 v19, v19
    v_rcp_f32 v20, v20
    v_rcp_f32 v21, v21
    v_rcp_f32 v22, v22
    v_rcp_f32 v23, v23
    v_pk_mul_f32 v[16:17], v[16:17], v[160:161]
    v_pk_mul_f32 v[18:19], v[18:19], v[162:163]
    v_pk_mul_f32 v[20:21], v[20:21], v[164:165]
    v_pk_mul_f32 v[22:23], v[22:23], v[166:167]
    v_cvt_pk_bf16_f32 v36, v16, v17
    v_cvt_pk_bf16_f32 v37, v18, v19
    v_cvt_pk_bf16_f32 v38, v20, v21
    v_cvt_pk_bf16_f32 v39, v22, v23
    buffer_store_dwordx4 v[36:39], v4, s[12:15], s60 offen offset:1024 sc1
    v_pk_mul_f32 v[8:9], v[192:193], v[192:193]
    v_pk_mul_f32 v[10:11], v[194:195], v[194:195]
    v_pk_mul_f32 v[12:13], v[196:197], v[196:197]
    v_pk_mul_f32 v[14:15], v[198:199], v[198:199]
    v_pk_fma_f32 v[8:9], v[8:9], s[62:63], v[2:3]
    v_pk_fma_f32 v[10:11], v[10:11], s[62:63], v[2:3]
    v_pk_fma_f32 v[12:13], v[12:13], s[62:63], v[2:3]
    v_pk_fma_f32 v[14:15], v[14:15], s[62:63], v[2:3]
    v_pk_mul_f32 v[8:9], v[8:9], v[192:193]
    v_pk_mul_f32 v[10:11], v[10:11], v[194:195]
    v_pk_mul_f32 v[12:13], v[12:13], v[196:197]
    v_pk_mul_f32 v[14:15], v[14:15], v[198:199]
    v_exp_f32 v8, v8
    v_exp_f32 v9, v9
    v_exp_f32 v10, v10
    v_exp_f32 v11, v11
    v_exp_f32 v12, v12
    v_exp_f32 v13, v13
    v_exp_f32 v14, v14
    v_exp_f32 v15, v15
    v_pk_add_f32 v[8:9], v[8:9], 1.0 op_sel_hi:[1,0]
    v_pk_add_f32 v[10:11], v[10:11], 1.0 op_sel_hi:[1,0]
    v_pk_add_f32 v[12:13], v[12:13], 1.0 op_sel_hi:[1,0]
    v_pk_add_f32 v[14:15], v[14:15], 1.0 op_sel_hi:[1,0]
    v_rcp_f32 v8, v8
    v_rcp_f32 v9, v9
    v_rcp_f32 v10, v10
    v_rcp_f32 v11, v11
    v_rcp_f32 v12, v12
    v_rcp_f32 v13, v13
    v_rcp_f32 v14, v14
    v_rcp_f32 v15, v15
    v_pk_mul_f32 v[8:9], v[8:9], v[192:193]
    v_pk_mul_f32 v[10:11], v[10:11], v[194:195]
    v_pk_mul_f32 v[12:13], v[12:13], v[196:197]
    v_pk_mul_f32 v[14:15], v[14:15], v[198:199]
    v_cvt_pk_bf16_f32 v40, v8, v9
    v_cvt_pk_bf16_f32 v41, v10, v11
    v_cvt_pk_bf16_f32 v42, v12, v13
    v_cvt_pk_bf16_f32 v43, v14, v15
    buffer_store_dwordx4 v[40:43], v4, s[12:15], s60 offen offset:2048 sc1
    v_pk_mul_f32 v[16:17], v[224:225], v[224:225]
    v_pk_mul_f32 v[18:19], v[226:227], v[226:227]
    v_pk_mul_f32 v[20:21], v[228:229], v[228:229]
    v_pk_mul_f32 v[22:23], v[230:231], v[230:231]
    v_pk_fma_f32 v[16:17], v[16:17], s[62:63], v[2:3]
    v_pk_fma_f32 v[18:19], v[18:19], s[62:63], v[2:3]
    v_pk_fma_f32 v[20:21], v[20:21], s[62:63], v[2:3]
    v_pk_fma_f32 v[22:23], v[22:23], s[62:63], v[2:3]
    v_pk_mul_f32 v[16:17], v[16:17], v[224:225]
    v_pk_mul_f32 v[18:19], v[18:19], v[226:227]
    v_pk_mul_f32 v[20:21], v[20:21], v[228:229]
    v_pk_mul_f32 v[22:23], v[22:23], v[230:231]
    v_exp_f32 v16, v16
    v_exp_f32 v17, v17
    v_exp_f32 v18, v18
    v_exp_f32 v19, v19
    v_exp_f32 v20, v20
    v_exp_f32 v21, v21
    v_exp_f32 v22, v22
    v_exp_f32 v23, v23
    v_pk_add_f32 v[16:17], v[16:17], 1.0 op_sel_hi:[1,0]
    v_pk_add_f32 v[18:19], v[18:19], 1.0 op_sel_hi:[1,0]
    v_pk_add_f32 v[20:21], v[20:21], 1.0 op_sel_hi:[1,0]
    v_pk_add_f32 v[22:23], v[22:23], 1.0 op_sel_hi:[1,0]
    v_rcp_f32 v16, v16
    v_rcp_f32 v17, v17
    v_rcp_f32 v18, v18
    v_rcp_f32 v19, v19
    v_rcp_f32 v20, v20
    v_rcp_f32 v21, v21
    v_rcp_f32 v22, v22
    v_rcp_f32 v23, v23
    v_pk_mul_f32 v[16:17], v[16:17], v[224:225]
    v_pk_mul_f32 v[18:19], v[18:19], v[226:227]
    v_pk_mul_f32 v[20:21], v[20:21], v[228:229]
    v_pk_mul_f32 v[22:23], v[22:23], v[230:231]
    v_cvt_pk_bf16_f32 v44, v16, v17
    v_cvt_pk_bf16_f32 v45, v18, v19
    v_cvt_pk_bf16_f32 v46, v20, v21
    v_cvt_pk_bf16_f32 v47, v22, v23
    buffer_store_dwordx4 v[44:47], v4, s[12:15], s60 offen offset:3072 sc1
    s_add_u32 s60, s60, 4096
    v_pk_mul_f32 v[8:9], v[136:137], v[136:137]
    v_pk_mul_f32 v[10:11], v[138:139], v[138:139]
    v_pk_mul_f32 v[12:13], v[140:141], v[140:141]
    v_pk_mul_f32 v[14:15], v[142:143], v[142:143]
    v_pk_fma_f32 v[8:9], v[8:9], s[62:63], v[2:3]
    v_pk_fma_f32 v[10:11], v[10:11], s[62:63], v[2:3]
    v_pk_fma_f32 v[12:13], v[12:13], s[62:63], v[2:3]
    v_pk_fma_f32 v[14:15], v[14:15], s[62:63], v[2:3]
    v_pk_mul_f32 v[8:9], v[8:9], v[136:137]
    v_pk_mul_f32 v[10:11], v[10:11], v[138:139]
    v_pk_mul_f32 v[12:13], v[12:13], v[140:141]
    v_pk_mul_f32 v[14:15], v[14:15], v[142:143]
    v_exp_f32 v8, v8
    v_exp_f32 v9, v9
    v_exp_f32 v10, v10
    v_exp_f32 v11, v11
    v_exp_f32 v12, v12
    v_exp_f32 v13, v13
    v_exp_f32 v14, v14
    v_exp_f32 v15, v15
    v_pk_add_f32 v[8:9], v[8:9], 1.0 op_sel_hi:[1,0]
    v_pk_add_f32 v[10:11], v[10:11], 1.0 op_sel_hi:[1,0]
    v_pk_add_f32 v[12:13], v[12:13], 1.0 op_sel_hi:[1,0]
    v_pk_add_f32 v[14:15], v[14:15], 1.0 op_sel_hi:[1,0]
    v_rcp_f32 v8, v8
    v_rcp_f32 v9, v9
    v_rcp_f32 v10, v10
    v_rcp_f32 v11, v11
    v_rcp_f32 v12, v12
    v_rcp_f32 v13, v13
    v_rcp_f32 v14, v14
    v_rcp_f32 v15, v15
    v_pk_mul_f32 v[8:9], v[8:9], v[136:137]
    v_pk_mul_f32 v[10:11], v[10:11], v[138:139]
    v_pk_mul_f32 v[12:13], v[12:13], v[140:141]
    v_pk_mul_f32 v[14:15], v[14:15], v[142:143]
    v_cvt_pk_bf16_f32 v32, v8, v9
    v_cvt_pk_bf16_f32 v33, v10, v11
    v_cvt_pk_bf16_f32 v34, v12, v13
    v_cvt_pk_bf16_f32 v35, v14, v15
    buffer_store_dwordx4 v[32:35], v4, s[12:15], s60 offen sc1
    v_pk_mul_f32 v[16:17], v[168:169], v[168:169]
    v_pk_mul_f32 v[18:19], v[170:171], v[170:171]
    v_pk_mul_f32 v[20:21], v[172:173], v[172:173]
    v_pk_mul_f32 v[22:23], v[174:175], v[174:175]
    v_pk_fma_f32 v[16:17], v[16:17], s[62:63], v[2:3]
    v_pk_fma_f32 v[18:19], v[18:19], s[62:63], v[2:3]
    v_pk_fma_f32 v[20:21], v[20:21], s[62:63], v[2:3]
    v_pk_fma_f32 v[22:23], v[22:23], s[62:63], v[2:3]
    v_pk_mul_f32 v[16:17], v[16:17], v[168:169]
    v_pk_mul_f32 v[18:19], v[18:19], v[170:171]
    v_pk_mul_f32 v[20:21], v[20:21], v[172:173]
    v_pk_mul_f32 v[22:23], v[22:23], v[174:175]
    v_exp_f32 v16, v16
    v_exp_f32 v17, v17
    v_exp_f32 v18, v18
    v_exp_f32 v19, v19
    v_exp_f32 v20, v20
    v_exp_f32 v21, v21
    v_exp_f32 v22, v22
    v_exp_f32 v23, v23
    v_pk_add_f32 v[16:17], v[16:17], 1.0 op_sel_hi:[1,0]
    v_pk_add_f32 v[18:19], v[18:19], 1.0 op_sel_hi:[1,0]
    v_pk_add_f32 v[20:21], v[20:21], 1.0 op_sel_hi:[1,0]
    v_pk_add_f32 v[22:23], v[22:23], 1.0 op_sel_hi:[1,0]
    v_rcp_f32 v16, v16
    v_rcp_f32 v17, v17
    v_rcp_f32 v18, v18
    v_rcp_f32 v19, v19
    v_rcp_f32 v20, v20
    v_rcp_f32 v21, v21
    v_rcp_f32 v22, v22
    v_rcp_f32 v23, v23
    v_pk_mul_f32 v[16:17], v[16:17], v[168:169]
    v_pk_mul_f32 v[18:19], v[18:19], v[170:171]
    v_pk_mul_f32 v[20:21], v[20:21], v[172:173]
    v_pk_mul_f32 v[22:23], v[22:23], v[174:175]
    v_cvt_pk_bf16_f32 v36, v16, v17
    v_cvt_pk_bf16_f32 v37, v18, v19
    v_cvt_pk_bf16_f32 v38, v20, v21
    v_cvt_pk_bf16_f32 v39, v22, v23
    buffer_store_dwordx4 v[36:39], v4, s[12:15], s60 offen offset:1024 sc1
    v_pk_mul_f32 v[8:9], v[200:201], v[200:201]
    v_pk_mul_f32 v[10:11], v[202:203], v[202:203]
    v_pk_mul_f32 v[12:13], v[204:205], v[204:205]
    v_pk_mul_f32 v[14:15], v[206:207], v[206:207]
    v_pk_fma_f32 v[8:9], v[8:9], s[62:63], v[2:3]
    v_pk_fma_f32 v[10:11], v[10:11], s[62:63], v[2:3]
    v_pk_fma_f32 v[12:13], v[12:13], s[62:63], v[2:3]
    v_pk_fma_f32 v[14:15], v[14:15], s[62:63], v[2:3]
    v_pk_mul_f32 v[8:9], v[8:9], v[200:201]
    v_pk_mul_f32 v[10:11], v[10:11], v[202:203]
    v_pk_mul_f32 v[12:13], v[12:13], v[204:205]
    v_pk_mul_f32 v[14:15], v[14:15], v[206:207]
    v_exp_f32 v8, v8
    v_exp_f32 v9, v9
    v_exp_f32 v10, v10
    v_exp_f32 v11, v11
    v_exp_f32 v12, v12
    v_exp_f32 v13, v13
    v_exp_f32 v14, v14
    v_exp_f32 v15, v15
    v_pk_add_f32 v[8:9], v[8:9], 1.0 op_sel_hi:[1,0]
    v_pk_add_f32 v[10:11], v[10:11], 1.0 op_sel_hi:[1,0]
    v_pk_add_f32 v[12:13], v[12:13], 1.0 op_sel_hi:[1,0]
    v_pk_add_f32 v[14:15], v[14:15], 1.0 op_sel_hi:[1,0]
    v_rcp_f32 v8, v8
    v_rcp_f32 v9, v9
    v_rcp_f32 v10, v10
    v_rcp_f32 v11, v11
    v_rcp_f32 v12, v12
    v_rcp_f32 v13, v13
    v_rcp_f32 v14, v14
    v_rcp_f32 v15, v15
    v_pk_mul_f32 v[8:9], v[8:9], v[200:201]
    v_pk_mul_f32 v[10:11], v[10:11], v[202:203]
    v_pk_mul_f32 v[12:13], v[12:13], v[204:205]
    v_pk_mul_f32 v[14:15], v[14:15], v[206:207]
    v_cvt_pk_bf16_f32 v40, v8, v9
    v_cvt_pk_bf16_f32 v41, v10, v11
    v_cvt_pk_bf16_f32 v42, v12, v13
    v_cvt_pk_bf16_f32 v43, v14, v15
    buffer_store_dwordx4 v[40:43], v4, s[12:15], s60 offen offset:2048 sc1
    v_pk_mul_f32 v[16:17], v[232:233], v[232:233]
    v_pk_mul_f32 v[18:19], v[234:235], v[234:235]
    v_pk_mul_f32 v[20:21], v[236:237], v[236:237]
    v_pk_mul_f32 v[22:23], v[238:239], v[238:239]
    v_pk_fma_f32 v[16:17], v[16:17], s[62:63], v[2:3]
    v_pk_fma_f32 v[18:19], v[18:19], s[62:63], v[2:3]
    v_pk_fma_f32 v[20:21], v[20:21], s[62:63], v[2:3]
    v_pk_fma_f32 v[22:23], v[22:23], s[62:63], v[2:3]
    v_pk_mul_f32 v[16:17], v[16:17], v[232:233]
    v_pk_mul_f32 v[18:19], v[18:19], v[234:235]
    v_pk_mul_f32 v[20:21], v[20:21], v[236:237]
    v_pk_mul_f32 v[22:23], v[22:23], v[238:239]
    v_exp_f32 v16, v16
    v_exp_f32 v17, v17
    v_exp_f32 v18, v18
    v_exp_f32 v19, v19
    v_exp_f32 v20, v20
    v_exp_f32 v21, v21
    v_exp_f32 v22, v22
    v_exp_f32 v23, v23
    v_pk_add_f32 v[16:17], v[16:17], 1.0 op_sel_hi:[1,0]
    v_pk_add_f32 v[18:19], v[18:19], 1.0 op_sel_hi:[1,0]
    v_pk_add_f32 v[20:21], v[20:21], 1.0 op_sel_hi:[1,0]
    v_pk_add_f32 v[22:23], v[22:23], 1.0 op_sel_hi:[1,0]
    v_rcp_f32 v16, v16
    v_rcp_f32 v17, v17
    v_rcp_f32 v18, v18
    v_rcp_f32 v19, v19
    v_rcp_f32 v20, v20
    v_rcp_f32 v21, v21
    v_rcp_f32 v22, v22
    v_rcp_f32 v23, v23
    v_pk_mul_f32 v[16:17], v[16:17], v[232:233]
    v_pk_mul_f32 v[18:19], v[18:19], v[234:235]
    v_pk_mul_f32 v[20:21], v[20:21], v[236:237]
    v_pk_mul_f32 v[22:23], v[22:23], v[238:239]
    v_cvt_pk_bf16_f32 v44, v16, v17
    v_cvt_pk_bf16_f32 v45, v18, v19
    v_cvt_pk_bf16_f32 v46, v20, v21
    v_cvt_pk_bf16_f32 v47, v22, v23
    buffer_store_dwordx4 v[44:47], v4, s[12:15], s60 offen offset:3072 sc1
    s_add_u32 s60, s60, 4096
    s_cmp_eq_u32 s25, 6
    s_cselect_b32 s48, s22, 0
    s_cmp_eq_u32 s48, 1
    s_cbranch_scc1 K_HDONE
    v_pk_mul_f32 v[8:9], v[144:145], v[144:145]
    v_pk_mul_f32 v[10:11], v[146:147], v[146:147]
    v_pk_mul_f32 v[12:13], v[148:149], v[148:149]
    v_pk_mul_f32 v[14:15], v[150:151], v[150:151]
    v_pk_fma_f32 v[8:9], v[8:9], s[62:63], v[2:3]
    v_pk_fma_f32 v[10:11], v[10:11], s[62:63], v[2:3]
    v_pk_fma_f32 v[12:13], v[12:13], s[62:63], v[2:3]
    v_pk_fma_f32 v[14:15], v[14:15], s[62:63], v[2:3]
    v_pk_mul_f32 v[8:9], v[8:9], v[144:145]
    v_pk_mul_f32 v[10:11], v[10:11], v[146:147]
    v_pk_mul_f32 v[12:13], v[12:13], v[148:149]
    v_pk_mul_f32 v[14:15], v[14:15], v[150:151]
    v_exp_f32 v8, v8
    v_exp_f32 v9, v9
    v_exp_f32 v10, v10
    v_exp_f32 v11, v11
    v_exp_f32 v12, v12
    v_exp_f32 v13, v13
    v_exp_f32 v14, v14
    v_exp_f32 v15, v15
    v_pk_add_f32 v[8:9], v[8:9], 1.0 op_sel_hi:[1,0]
    v_pk_add_f32 v[10:11], v[10:11], 1.0 op_sel_hi:[1,0]
    v_pk_add_f32 v[12:13], v[12:13], 1.0 op_sel_hi:[1,0]
    v_pk_add_f32 v[14:15], v[14:15], 1.0 op_sel_hi:[1,0]
    v_rcp_f32 v8, v8
    v_rcp_f32 v9, v9
    v_rcp_f32 v10, v10
    v_rcp_f32 v11, v11
    v_rcp_f32 v12, v12
    v_rcp_f32 v13, v13
    v_rcp_f32 v14, v14
    v_rcp_f32 v15, v15
    v_pk_mul_f32 v[8:9], v[8:9], v[144:145]
    v_pk_mul_f32 v[10:11], v[10:11], v[146:147]
    v_pk_mul_f32 v[12:13], v[12:13], v[148:149]
    v_pk_mul_f32 v[14:15], v[14:15], v[150:151]
    v_cvt_pk_bf16_f32 v32, v8, v9
    v_cvt_pk_bf16_f32 v33, v10, v11
    v_cvt_pk_bf16_f32 v34, v12, v13
    v_cvt_pk_bf16_f32 v35, v14, v15
    buffer_store_dwordx4 v[32:35], v4, s[12:15], s60 offen sc1
    v_pk_mul_f32 v[16:17], v[176:177], v[176:177]
    v_pk_mul_f32 v[18:19], v[178:179], v[178:179]
    v_pk_mul_f32 v[20:21], v[180:181], v[180:181]
    v_pk_mul_f32 v[22:23], v[182:183], v[182:183]
    v_pk_fma_f32 v[16:17], v[16:17], s[62:63], v[2:3]
    v_pk_fma_f32 v[18:19], v[18:19], s[62:63], v[2:3]
    v_pk_fma_f32 v[20:21], v[20:21], s[62:63], v[2:3]
    v_pk_fma_f32 v[22:23], v[22:23], s[62:63], v[2:3]
    v_pk_mul_f32 v[16:17], v[16:17], v[176:177]
    v_pk_mul_f32 v[18:19], v[18:19], v[178:179]
    v_pk_mul_f32 v[20:21], v[20:21], v[180:181]
    v_pk_mul_f32 v[22:23], v[22:23], v[182:183]
    v_exp_f32 v16, v16
    v_exp_f32 v17, v17
    v_exp_f32 v18, v18
    v_exp_f32 v19, v19
    v_exp_f32 v20, v20
    v_exp_f32 v21, v21
    v_exp_f32 v22, v22
    v_exp_f32 v23, v23
    v_pk_add_f32 v[16:17], v[16:17], 1.0 op_sel_hi:[1,0]
    v_pk_add_f32 v[18:19], v[18:19], 1.0 op_sel_hi:[1,0]
    v_pk_add_f32 v[20:21], v[20:21], 1.0 op_sel_hi:[1,0]
    v_pk_add_f32 v[22:23], v[22:23], 1.0 op_sel_hi:[1,0]
    v_rcp_f32 v16, v16
    v_rcp_f32 v17, v17
    v_rcp_f32 v18, v18
    v_rcp_f32 v19, v19
    v_rcp_f32 v20, v20
    v_rcp_f32 v21, v21
    v_rcp_f32 v22, v22
    v_rcp_f32 v23, v23
    v_pk_mul_f32 v[16:17], v[16:17], v[176:177]
    v_pk_mul_f32 v[18:19], v[18:19], v[178:179]
    v_pk_mul_f32 v[20:21], v[20:21], v[180:181]
    v_pk_mul_f32 v[22:23], v[22:23], v[182:183]
    v_cvt_pk_bf16_f32 v36, v16, v17
    v_cvt_pk_bf16_f32 v37, v18, v19
    v_cvt_pk_bf16_f32 v38, v20, v21
    v_cvt_pk_bf16_f32 v39, v22, v23
    buffer_store_dwordx4 v[36:39], v4, s[12:15], s60 offen offset:1024 sc1
    v_pk_mul_f32 v[8:9], v[208:209], v[208:209]
    v_pk_mul_f32 v[10:11], v[210:211], v[210:211]
    v_pk_mul_f32 v[12:13], v[212:213], v[212:213]
    v_pk_mul_f32 v[14:15], v[214:215], v[214:215]
    v_pk_fma_f32 v[8:9], v[8:9], s[62:63], v[2:3]
    v_pk_fma_f32 v[10:11], v[10:11], s[62:63], v[2:3]
    v_pk_fma_f32 v[12:13], v[12:13], s[62:63], v[2:3]
    v_pk_fma_f32 v[14:15], v[14:15], s[62:63], v[2:3]
    v_pk_mul_f32 v[8:9], v[8:9], v[208:209]
    v_pk_mul_f32 v[10:11], v[10:11], v[210:211]
    v_pk_mul_f32 v[12:13], v[12:13], v[212:213]
    v_pk_mul_f32 v[14:15], v[14:15], v[214:215]
    v_exp_f32 v8, v8
    v_exp_f32 v9, v9
    v_exp_f32 v10, v10
    v_exp_f32 v11, v11
    v_exp_f32 v12, v12
    v_exp_f32 v13, v13
    v_exp_f32 v14, v14
    v_exp_f32 v15, v15
    v_pk_add_f32 v[8:9], v[8:9], 1.0 op_sel_hi:[1,0]
    v_pk_add_f32 v[10:11], v[10:11], 1.0 op_sel_hi:[1,0]
    v_pk_add_f32 v[12:13], v[12:13], 1.0 op_sel_hi:[1,0]
    v_pk_add_f32 v[14:15], v[14:15], 1.0 op_sel_hi:[1,0]
    v_rcp_f32 v8, v8
    v_rcp_f32 v9, v9
    v_rcp_f32 v10, v10
    v_rcp_f32 v11, v11
    v_rcp_f32 v12, v12
    v_rcp_f32 v13, v13
    v_rcp_f32 v14, v14
    v_rcp_f32 v15, v15
    v_pk_mul_f32 v[8:9], v[8:9], v[208:209]
    v_pk_mul_f32 v[10:11], v[10:11], v[210:211]
    v_pk_mul_f32 v[12:13], v[12:13], v[212:213]
    v_pk_mul_f32 v[14:15], v[14:15], v[214:215]
    v_cvt_pk_bf16_f32 v40, v8, v9
    v_cvt_pk_bf16_f32 v41, v10, v11
    v_cvt_pk_bf16_f32 v42, v12, v13
    v_cvt_pk_bf16_f32 v43, v14, v15
    buffer_store_dwordx4 v[40:43], v4, s[12:15], s60 offen offset:2048 sc1
    v_pk_mul_f32 v[16:17], v[240:241], v[240:241]
    v_pk_mul_f32 v[18:19], v[242:243], v[242:243]
    v_pk_mul_f32 v[20:21], v[244:245], v[244:245]
    v_pk_mul_f32 v[22:23], v[246:247], v[246:247]
    v_pk_fma_f32 v[16:17], v[16:17], s[62:63], v[2:3]
    v_pk_fma_f32 v[18:19], v[18:19], s[62:63], v[2:3]
    v_pk_fma_f32 v[20:21], v[20:21], s[62:63], v[2:3]
    v_pk_fma_f32 v[22:23], v[22:23], s[62:63], v[2:3]
    v_pk_mul_f32 v[16:17], v[16:17], v[240:241]
    v_pk_mul_f32 v[18:19], v[18:19], v[242:243]
    v_pk_mul_f32 v[20:21], v[20:21], v[244:245]
    v_pk_mul_f32 v[22:23], v[22:23], v[246:247]
    v_exp_f32 v16, v16
    v_exp_f32 v17, v17
    v_exp_f32 v18, v18
    v_exp_f32 v19, v19
    v_exp_f32 v20, v20
    v_exp_f32 v21, v21
    v_exp_f32 v22, v22
    v_exp_f32 v23, v23
    v_pk_add_f32 v[16:17], v[16:17], 1.0 op_sel_hi:[1,0]
    v_pk_add_f32 v[18:19], v[18:19], 1.0 op_sel_hi:[1,0]
    v_pk_add_f32 v[20:21], v[20:21], 1.0 op_sel_hi:[1,0]
    v_pk_add_f32 v[22:23], v[22:23], 1.0 op_sel_hi:[1,0]
    v_rcp_f32 v16, v16
    v_rcp_f32 v17, v17
    v_rcp_f32 v18, v18
    v_rcp_f32 v19, v19
    v_rcp_f32 v20, v20
    v_rcp_f32 v21, v21
    v_rcp_f32 v22, v22
    v_rcp_f32 v23, v23
    v_pk_mul_f32 v[16:17], v[16:17], v[240:241]
    v_pk_mul_f32 v[18:19], v[18:19], v[242:243]
    v_pk_mul_f32 v[20:21], v[20:21], v[244:245]
    v_pk_mul_f32 v[22:23], v[22:23], v[246:247]
    v_cvt_pk_bf16_f32 v44, v16, v17
    v_cvt_pk_bf16_f32 v45, v18, v19
    v_cvt_pk_bf16_f32 v46, v20, v21
    v_cvt_pk_bf16_f32 v47, v22, v23
    buffer_store_dwordx4 v[44:47], v4, s[12:15], s60 offen offset:3072 sc1
    s_add_u32 s60, s60, 4096
    v_pk_mul_f32 v[8:9], v[152:153], v[152:153]
    v_pk_mul_f32 v[10:11], v[154:155], v[154:155]
    v_pk_mul_f32 v[12:13], v[156:157], v[156:157]
    v_pk_mul_f32 v[14:15], v[158:159], v[158:159]
    v_pk_fma_f32 v[8:9], v[8:9], s[62:63], v[2:3]
    v_pk_fma_f32 v[10:11], v[10:11], s[62:63], v[2:3]
    v_pk_fma_f32 v[12:13], v[12:13], s[62:63], v[2:3]
    v_pk_fma_f32 v[14:15], v[14:15], s[62:63], v[2:3]
    v_pk_mul_f32 v[8:9], v[8:9], v[152:153]
    v_pk_mul_f32 v[10:11], v[10:11], v[154:155]
    v_pk_mul_f32 v[12:13], v[12:13], v[156:157]
    v_pk_mul_f32 v[14:15], v[14:15], v[158:159]
    v_exp_f32 v8, v8
    v_exp_f32 v9, v9
    v_exp_f32 v10, v10
    v_exp_f32 v11, v11
    v_exp_f32 v12, v12
    v_exp_f32 v13, v13
    v_exp_f32 v14, v14
    v_exp_f32 v15, v15
    v_pk_add_f32 v[8:9], v[8:9], 1.0 op_sel_hi:[1,0]
    v_pk_add_f32 v[10:11], v[10:11], 1.0 op_sel_hi:[1,0]
    v_pk_add_f32 v[12:13], v[12:13], 1.0 op_sel_hi:[1,0]
    v_pk_add_f32 v[14:15], v[14:15], 1.0 op_sel_hi:[1,0]
    v_rcp_f32 v8, v8
    v_rcp_f32 v9, v9
    v_rcp_f32 v10, v10
    v_rcp_f32 v11, v11
    v_rcp_f32 v12, v12
    v_rcp_f32 v13, v13
    v_rcp_f32 v14, v14
    v_rcp_f32 v15, v15
    v_pk_mul_f32 v[8:9], v[8:9], v[152:153]
    v_pk_mul_f32 v[10:11], v[10:11], v[154:155]
    v_pk_mul_f32 v[12:13], v[12:13], v[156:157]
    v_pk_mul_f32 v[14:15], v[14:15], v[158:159]
    v_cvt_pk_bf16_f32 v32, v8, v9
    v_cvt_pk_bf16_f32 v33, v10, v11
    v_cvt_pk_bf16_f32 v34, v12, v13
    v_cvt_pk_bf16_f32 v35, v14, v15
    buffer_store_dwordx4 v[32:35], v4, s[12:15], s60 offen sc1
    v_pk_mul_f32 v[16:17], v[184:185], v[184:185]
    v_pk_mul_f32 v[18:19], v[186:187], v[186:187]
    v_pk_mul_f32 v[20:21], v[188:189], v[188:189]
    v_pk_mul_f32 v[22:23], v[190:191], v[190:191]
    v_pk_fma_f32 v[16:17], v[16:17], s[62:63], v[2:3]
    v_pk_fma_f32 v[18:19], v[18:19], s[62:63], v[2:3]
    v_pk_fma_f32 v[20:21], v[20:21], s[62:63], v[2:3]
    v_pk_fma_f32 v[22:23], v[22:23], s[62:63], v[2:3]
    v_pk_mul_f32 v[16:17], v[16:17], v[184:185]
    v_pk_mul_f32 v[18:19], v[18:19], v[186:187]
    v_pk_mul_f32 v[20:21], v[20:21], v[188:189]
    v_pk_mul_f32 v[22:23], v[22:23], v[190:191]
    v_exp_f32 v16, v16
    v_exp_f32 v17, v17
    v_exp_f32 v18, v18
    v_exp_f32 v19, v19
    v_exp_f32 v20, v20
    v_exp_f32 v21, v21
    v_exp_f32 v22, v22
    v_exp_f32 v23, v23
    v_pk_add_f32 v[16:17], v[16:17], 1.0 op_sel_hi:[1,0]
    v_pk_add_f32 v[18:19], v[18:19], 1.0 op_sel_hi:[1,0]
    v_pk_add_f32 v[20:21], v[20:21], 1.0 op_sel_hi:[1,0]
    v_pk_add_f32 v[22:23], v[22:23], 1.0 op_sel_hi:[1,0]
    v_rcp_f32 v16, v16
    v_rcp_f32 v17, v17
    v_rcp_f32 v18, v18
    v_rcp_f32 v19, v19
    v_rcp_f32 v20, v20
    v_rcp_f32 v21, v21
    v_rcp_f32 v22, v22
    v_rcp_f32 v23, v23
    v_pk_mul_f32 v[16:17], v[16:17], v[184:185]
    v_pk_mul_f32 v[18:19], v[18:19], v[186:187]
    v_pk_mul_f32 v[20:21], v[20:21], v[188:189]
    v_pk_mul_f32 v[22:23], v[22:23], v[190:191]
    v_cvt_pk_bf16_f32 v36, v16, v17
    v_cvt_pk_bf16_f32 v37, v18, v19
    v_cvt_pk_bf16_f32 v38, v20, v21
    v_cvt_pk_bf16_f32 v39, v22, v23
    buffer_store_dwordx4 v[36:39], v4, s[12:15], s60 offen offset:1024 sc1
    v_pk_mul_f32 v[8:9], v[216:217], v[216:217]
    v_pk_mul_f32 v[10:11], v[218:219], v[218:219]
    v_pk_mul_f32 v[12:13], v[220:221], v[220:221]
    v_pk_mul_f32 v[14:15], v[222:223], v[222:223]
    v_pk_fma_f32 v[8:9], v[8:9], s[62:63], v[2:3]
    v_pk_fma_f32 v[10:11], v[10:11], s[62:63], v[2:3]
    v_pk_fma_f32 v[12:13], v[12:13], s[62:63], v[2:3]
    v_pk_fma_f32 v[14:15], v[14:15], s[62:63], v[2:3]
    v_pk_mul_f32 v[8:9], v[8:9], v[216:217]
    v_pk_mul_f32 v[10:11], v[10:11], v[218:219]
    v_pk_mul_f32 v[12:13], v[12:13], v[220:221]
    v_pk_mul_f32 v[14:15], v[14:15], v[222:223]
    v_exp_f32 v8, v8
    v_exp_f32 v9, v9
    v_exp_f32 v10, v10
    v_exp_f32 v11, v11
    v_exp_f32 v12, v12
    v_exp_f32 v13, v13
    v_exp_f32 v14, v14
    v_exp_f32 v15, v15
    v_pk_add_f32 v[8:9], v[8:9], 1.0 op_sel_hi:[1,0]
    v_pk_add_f32 v[10:11], v[10:11], 1.0 op_sel_hi:[1,0]
    v_pk_add_f32 v[12:13], v[12:13], 1.0 op_sel_hi:[1,0]
    v_pk_add_f32 v[14:15], v[14:15], 1.0 op_sel_hi:[1,0]
    v_rcp_f32 v8, v8
    v_rcp_f32 v9, v9
    v_rcp_f32 v10, v10
    v_rcp_f32 v11, v11
    v_rcp_f32 v12, v12
    v_rcp_f32 v13, v13
    v_rcp_f32 v14, v14
    v_rcp_f32 v15, v15
    v_pk_mul_f32 v[8:9], v[8:9], v[216:217]
    v_pk_mul_f32 v[10:11], v[10:11], v[218:219]
    v_pk_mul_f32 v[12:13], v[12:13], v[220:221]
    v_pk_mul_f32 v[14:15], v[14:15], v[222:223]
    v_cvt_pk_bf16_f32 v40, v8, v9
    v_cvt_pk_bf16_f32 v41, v10, v11
    v_cvt_pk_bf16_f32 v42, v12, v13
    v_cvt_pk_bf16_f32 v43, v14, v15
    buffer_store_dwordx4 v[40:43], v4, s[12:15], s60 offen offset:2048 sc1
    v_pk_mul_f32 v[16:17], v[248:249], v[248:249]
    v_pk_mul_f32 v[18:19], v[250:251], v[250:251]
    v_pk_mul_f32 v[20:21], v[252:253], v[252:253]
    v_pk_mul_f32 v[22:23], v[254:255], v[254:255]
    v_pk_fma_f32 v[16:17], v[16:17], s[62:63], v[2:3]
    v_pk_fma_f32 v[18:19], v[18:19], s[62:63], v[2:3]
    v_pk_fma_f32 v[20:21], v[20:21], s[62:63], v[2:3]
    v_pk_fma_f32 v[22:23], v[22:23], s[62:63], v[2:3]
    v_pk_mul_f32 v[16:17], v[16:17], v[248:249]
    v_pk_mul_f32 v[18:19], v[18:19], v[250:251]
    v_pk_mul_f32 v[20:21], v[20:21], v[252:253]
    v_pk_mul_f32 v[22:23], v[22:23], v[254:255]
    v_exp_f32 v16, v16
    v_exp_f32 v17, v17
    v_exp_f32 v18, v18
    v_exp_f32 v19, v19
    v_exp_f32 v20, v20
    v_exp_f32 v21, v21
    v_exp_f32 v22, v22
    v_exp_f32 v23, v23
    v_pk_add_f32 v[16:17], v[16:17], 1.0 op_sel_hi:[1,0]
    v_pk_add_f32 v[18:19], v[18:19], 1.0 op_sel_hi:[1,0]
    v_pk_add_f32 v[20:21], v[20:21], 1.0 op_sel_hi:[1,0]
    v_pk_add_f32 v[22:23], v[22:23], 1.0 op_sel_hi:[1,0]
    v_rcp_f32 v16, v16
    v_rcp_f32 v17, v17
    v_rcp_f32 v18, v18
    v_rcp_f32 v19, v19
    v_rcp_f32 v20, v20
    v_rcp_f32 v21, v21
    v_rcp_f32 v22, v22
    v_rcp_f32 v23, v23
    v_pk_mul_f32 v[16:17], v[16:17], v[248:249]
    v_pk_mul_f32 v[18:19], v[18:19], v[250:251]
    v_pk_mul_f32 v[20:21], v[20:21], v[252:253]
    v_pk_mul_f32 v[22:23], v[22:23], v[254:255]
    v_cvt_pk_bf16_f32 v44, v16, v17
    v_cvt_pk_bf16_f32 v45, v18, v19
    v_cvt_pk_bf16_f32 v46, v20, v21
    v_cvt_pk_bf16_f32 v47, v22, v23
    buffer_store_dwordx4 v[44:47], v4, s[12:15], s60 offen offset:3072 sc1
    s_add_u32 s60, s60, 4096
K_HDONE:
K_ARRIVE:
    s_load_dwordx2 s[16:17], s[0:1], 56
    s_load_dwordx2 s[12:13], s[0:1], 72
    s_load_dwordx2 s[4:5], s[0:1], 88
    v_mov_b32 v240, v1
    v_lshlrev_b32 v233, 4, v1
    s_and_b32 s26, s2, 7
    s_lshr_b32 s27, s2, 3
    s_lshr_b32 s21, s26, 1
    s_lshl_b32 s21, s21, 3
    s_and_b32 s28, s27, 7
    s_add_u32 s21, s21, s28
    s_and_b32 s22, s26, 1
    s_lshl_b32 s22, s22, 2
    s_lshr_b32 s28, s27, 3
    s_add_u32 s22, s22, s28
    s_mul_i32 s25, s20, 35840
    s_mul_i32 s26, s20, 18
    s_mul_i32 s23, s21, 74
    s_add_u32 s23, s23, s26
    s_lshl_b32 s23, s23, 12
    s_add_u32 s26, s20, 0
    s_and_b32 s26, s26, 3
    s_lshl_b32 s26, s26, 10
    v_add_u32 v188, s26, v233
    s_add_u32 s26, s20, 1
    s_and_b32 s26, s26, 3
    s_lshl_b32 s26, s26, 10
    v_add_u32 v189, s26, v233
    s_add_u32 s26, s20, 2
    s_and_b32 s26, s26, 3
    s_lshl_b32 s26, s26, 10
    v_add_u32 v190, s26, v233
    s_add_u32 s26, s20, 3
    s_and_b32 s26, s26, 3
    s_lshl_b32 s26, s26, 10
    v_add_u32 v191, s26, v233
    v_add_u32 v193, s25, v233
    v_mov_b32 v238, v193
    v_mov_b32 v192, v233
    v_add_u32 v241, 4096, v233
    s_mul_i32 s24, s20, 18
    s_cmp_eq_u32 s20, 3
    s_cselect_b32 s26, 7, 7
    s_add_u32 s24, s24, s26
    s_mul_i32 s24, s24, 40960
    s_mul_i32 s27, s22, 5120
    s_add_u32 s24, s24, s27
    s_add_u32 s24, s24, 10485760
    s_add_u32 s26, s20, 1
    s_cmp_ge_u32 s26, 3
    s_cselect_b32 s27, 3, 0
    s_sub_u32 s26, s26, s27
    s_cmp_eq_u32 s20, 3
    s_cselect_b32 s40, 0, s26
    s_sub_u32 s27, s20, s40
    s_and_b32 s27, s27, 3
    s_sub_u32 s27, s27, 1
    s_mul_i32 s27, s27, 5120
    s_mul_i32 s26, s40, 35840
    s_add_u32 s26, s26, s27
    v_add_u32 v235, s26, v233
    s_add_u32 s26, s20, 2
    s_cmp_ge_u32 s26, 3
    s_cselect_b32 s27, 3, 0
    s_sub_u32 s26, s26, s27
    s_cmp_eq_u32 s20, 3
    s_cselect_b32 s41, 1, s26
    s_sub_u32 s27, s20, s41
    s_and_b32 s27, s27, 3
    s_sub_u32 s27, s27, 1
    s_mul_i32 s27, s27, 5120
    s_mul_i32 s26, s41, 35840
    s_add_u32 s26, s26, s27
    v_add_u32 v236, s26, v233
    s_mov_b32 s26, 3
    s_cmp_eq_u32 s20, 3
    s_cselect_b32 s42, 2, s26
    s_sub_u32 s27, s20, s42
    s_and_b32 s27, s27, 3
    s_sub_u32 s27, s27, 1
    s_mul_i32 s27, s27, 5120
    s_mul_i32 s26, s42, 35840
    s_add_u32 s26, s26, s27
    v_add_u32 v237, s26, v233
    v_and_b32 v227, 15, v240
    v_lshrrev_b32 v228, 4, v240
    s_lshl_b32 s26, s21, 6
    s_lshl_b32 s27, s20, 4
    s_add_u32 s26, s26, s27
    v_add_u32 v227, s26, v227
    v_mul_u32_u24 v234, 1280, v227
    s_mul_i32 s27, s22, 160
    v_lshl_add_u32 v229, v228, 3, s27
    v_add_u32 v234, v234, v229
    v_lshlrev_b32 v227, 3, v227
    v_add_u32 v227, 13631488, v227
    s_waitcnt lgkmcnt(0)
    s_mov_b32 s6, 13762560
    s_mov_b32 s7, 0x20000
    s_mov_b32 s14, 2621440
    s_mov_b32 s15, 0x20000
    s_mov_b32 s18, 1280
    s_mov_b32 s19, 0x20000
    buffer_load_dwordx2 v[216:217], v229, s[16:19], 0 offen offset:0
    buffer_load_dwordx2 v[218:219], v229, s[16:19], 0 offen offset:32
    buffer_load_dwordx2 v[220:221], v229, s[16:19], 0 offen offset:64
    buffer_load_dwordx2 v[222:223], v229, s[16:19], 0 offen offset:96
    buffer_load_dwordx2 v[224:225], v229, s[16:19], 0 offen offset:128
    v_mov_b32 v0, 0
    v_mov_b32 v1, 0
    v_mov_b32 v2, 0
    v_mov_b32 v3, 0
    v_mov_b32 v4, 0
    v_mov_b32 v5, 0
    v_mov_b32 v6, 0
    v_mov_b32 v7, 0
    v_mov_b32 v8, 0
    v_mov_b32 v9, 0
    v_mov_b32 v10, 0
    v_mov_b32 v11, 0
    v_mov_b32 v12, 0
    v_mov_b32 v13, 0
    v_mov_b32 v14, 0
    v_mov_b32 v15, 0
    v_mov_b32 v16, 0
    v_mov_b32 v17, 0
    v_mov_b32 v18, 0
    v_mov_b32 v19, 0
    v_mov_b32 v20, 0
    v_mov_b32 v21, 0
    v_mov_b32 v22, 0
    v_mov_b32 v23, 0
    v_mov_b32 v24, 0
    v_mov_b32 v25, 0
    v_mov_b32 v26, 0
    v_mov_b32 v27, 0
    v_mov_b32 v28, 0
    v_mov_b32 v29, 0
    v_mov_b32 v30, 0
    v_mov_b32 v31, 0
    v_mov_b32 v32, 0
    v_mov_b32 v33, 0
    v_mov_b32 v34, 0
    v_mov_b32 v35, 0
    v_mov_b32 v36, 0
    v_mov_b32 v37, 0
    v_mov_b32 v38, 0
    v_mov_b32 v39, 0
    v_mov_b32 v40, 0
    v_mov_b32 v41, 0
    v_mov_b32 v42, 0
    v_mov_b32 v43, 0
    v_mov_b32 v44, 0
    v_mov_b32 v45, 0
    v_mov_b32 v46, 0
    v_mov_b32 v47, 0
    v_mov_b32 v48, 0
    v_mov_b32 v49, 0
    v_mov_b32 v50, 0
    v_mov_b32 v51, 0
    v_mov_b32 v52, 0
    v_mov_b32 v53, 0
    v_mov_b32 v54, 0
    v_mov_b32 v55, 0
    v_mov_b32 v56, 0
    v_mov_b32 v57, 0
    v_mov_b32 v58, 0
    v_mov_b32 v59, 0
    v_mov_b32 v60, 0
    v_mov_b32 v61, 0
    v_mov_b32 v62, 0
    v_mov_b32 v63, 0
    v_mov_b32 v64, 0
    v_mov_b32 v65, 0
    v_mov_b32 v66, 0
    v_mov_b32 v67, 0
    v_mov_b32 v68, 0
    v_mov_b32 v69, 0
    v_mov_b32 v70, 0
    v_mov_b32 v71, 0
    v_mov_b32 v72, 0
    v_mov_b32 v73, 0
    v_mov_b32 v74, 0
    v_mov_b32 v75, 0
    v_mov_b32 v76, 0
    v_mov_b32 v77, 0
    v_mov_b32 v78, 0
    v_mov_b32 v79, 0
    s_lshr_b32 s48, s21, 1
    s_and_b32 s49, s48, 7
    v_lshl_add_u32 v82, v240, 3, s49
    s_movk_i32 s51, 4682
    v_mul_u32_u24 v83, s51, v82
    v_lshrrev_b32 v83, 16, v83
    v_mul_u32_u24 v84, 14, v83
    v_sub_u32 v84, v82, v84
    v_add_u32 v84, 18, v84
    s_lshr_b32 s48, s48, 3
    s_lshl_b32 s48, s48, 2
    v_add_u32 v83, s48, v83
    v_lshl_add_u32 v85, v84, 3, v83
    s_lshl_b32 s48, s21, 6
    v_bfe_u32 v82, v240, 4, 1
    v_mul_u32_u24 v82, 63, v82
    v_add_u32 v82, s48, v82
    v_max_u32 v83, 14, v82
    v_subrev_u32 v83, 14, v83
    s_movk_i32 s51, 575
    v_mul_u32_u24 v83, s51, v83
    v_lshrrev_b32 v83, 16, v83
    s_movk_i32 s51, 128
    v_cmp_gt_u32 vcc, s51, v82
    s_nop 1
    v_cndmask_b32_e64 v83, v83, 0, vcc
    v_cmp_le_u32 vcc, 9, v83
    v_mov_b32 v84, 0
    s_nop 0
    v_addc_co_u32 v84, vcc, 0, v84, vcc
    v_mul_u32_u24 v82, 9, v84
    v_sub_u32 v82, v83, v82
    v_and_b32 v83, 7, v240
    v_and_b32 v86, 1, v83
    v_lshl_add_u32 v82, v82, 1, v86
    v_lshrrev_b32 v83, 1, v83
    v_lshl_add_u32 v83, v84, 2, v83
    v_lshl_add_u32 v82, v82, 3, v83
    v_cmp_gt_u32 vcc, 8, v240
    s_nop 1
    v_cndmask_b32 v82, v82, v85, vcc
    v_lshlrev_b32 v82, 7, v82
    v_add_u32 v82, 13697028, v82
    s_mov_b32 s56, 0x00ffff7f
    s_mov_b32 s57, 0
    v_mov_b32 v83, 0x40000000
    v_cndmask_b32_e64 v82, v83, v82, s[56:57]
    s_mov_b32 s49, 1
    s_lshl_b32 s48, s2, 7
    s_add_u32 s48, s48, 13697028
    v_mov_b32 v84, s48
    v_mov_b32 v80, 147472
    v_mov_b32 v81, 1
    s_mov_b32 s50, 2097152
K_SPINS_21:
    ds_read_b32 v85, v80
    s_sub_u32 s50, s50, 1
    s_cmp_eq_u32 s50, 0
    s_cbranch_scc1 K_SPINDS_22
    s_waitcnt lgkmcnt(0)
    v_cmp_ne_u32 vcc, 1, v85
    s_nop 3
    s_cbranch_vccnz K_SPINS_21
K_SPINDS_22:
    s_waitcnt lgkmcnt(0)
    v_mov_b32 v80, 147464
    s_waitcnt vmcnt(0)
    s_mov_b64 exec, 1
    ds_add_rtn_u32 v85, v80, v81
    s_waitcnt lgkmcnt(0)
    v_readfirstlane_b32 s48, v85
    s_nop 3
    s_cmp_lg_u32 s48, 3
    s_cbranch_scc1 K_NOSIG
    buffer_store_dword v81, v84, s[4:7], 0 offen sc1
K_NOSIG:
    s_mov_b64 exec, -1
    s_cmp_lg_u32 s20, 0
    s_cbranch_scc1 K_P2GO
    s_mov_b32 s49, 1
    s_mov_b32 s50, 131072
K_POLLF2_23:
    buffer_load_dword v83, v82, s[4:7], 0 offen sc1
    s_sub_u32 s50, s50, 1
    s_cmp_eq_u32 s50, 0
    s_cbranch_scc1 K_POLLDF2_24
    s_waitcnt vmcnt(0)
    v_cmp_ne_u32 vcc, s49, v83
    s_nop 3
    s_and_b64 vcc, vcc, s[56:57]
    s_cbranch_scc1 K_POLLF2_23
K_POLLDF2_24:
    s_waitcnt vmcnt(0)
    v_mov_b32 v80, 147504
    v_mov_b32 v81, 1
    ds_write_b32 v80, v81
    s_branch K_P2GO2
K_P2GO:
    v_mov_b32 v80, 147504
    s_mov_b32 s50, 2097152
K_SPINGO_25:
    ds_read_b32 v81, v80
    s_sub_u32 s50, s50, 1
    s_cmp_eq_u32 s50, 0
    s_cbranch_scc1 K_SPINDGO_26
    s_waitcnt lgkmcnt(0)
    v_cmp_ne_u32 vcc, 1, v81
    s_nop 3
    s_cbranch_vccnz K_SPINGO_25
K_SPINDGO_26:
    s_waitcnt lgkmcnt(0)
K_P2GO2:
    buffer_load_dwordx4 v[80:83], v188, s[4:7], s23 offen sc1
    buffer_load_dwordx4 v[84:87], v189, s[4:7], s23 offen sc1
    buffer_load_dwordx4 v[88:91], v190, s[4:7], s23 offen sc1
    buffer_load_dwordx4 v[92:95], v191, s[4:7], s23 offen sc1
    s_add_u32 s23, s23, 4096
    buffer_load_dwordx4 v[116:119], v188, s[4:7], s23 offen sc1
    buffer_load_dwordx4 v[120:123], v189, s[4:7], s23 offen sc1
    buffer_load_dwordx4 v[124:127], v190, s[4:7], s23 offen sc1
    buffer_load_dwordx4 v[128:131], v191, s[4:7], s23 offen sc1
    s_add_u32 s23, s23, 4096
    buffer_load_dwordx4 v[152:155], v188, s[4:7], s23 offen sc1
    buffer_load_dwordx4 v[156:159], v189, s[4:7], s23 offen sc1
    buffer_load_dwordx4 v[160:163], v190, s[4:7], s23 offen sc1
    buffer_load_dwordx4 v[164:167], v191, s[4:7], s23 offen sc1
    s_add_u32 s23, s23, 4096
    s_cmp_eq_u32 s20, 3
    s_cbranch_scc1 K2_OSTREAM
K2_HSTREAM:
    s_lshl_b32 s26, s20, 2
    s_add_u32 s26, s26, 147520
    v_mov_b32 v230, s26
    s_mov_b32 s50, 2097152
K_SPINBAHSTREAM_27:
    ds_read_b32 v231, v230
    s_sub_u32 s50, s50, 1
    s_cmp_eq_u32 s50, 0
    s_cbranch_scc1 K_SPINDBAHSTREAM_28
    s_waitcnt lgkmcnt(0)
    v_cmp_gt_u32 vcc, 3, v231
    s_nop 3
    s_cbranch_vccnz K_SPINBAHSTREAM_27
K_SPINDBAHSTREAM_28:
    s_waitcnt lgkmcnt(0)
    ds_read_b128 v[96:99], v193 offset:0
    ds_read_b128 v[100:103], v193 offset:1024
    ds_read_b128 v[104:107], v193 offset:2048
    ds_read_b128 v[108:111], v193 offset:3072
    ds_read_b128 v[112:115], v193 offset:4096
    s_waitcnt vmcnt(8) lgkmcnt(0)
    v_mfma_f32_16x16x32_bf16 v[0:3], v[96:99], v[80:83], v[0:3]
    ds_read_b128 v[132:135], v193 offset:5120
    v_mfma_f32_16x16x32_bf16 v[4:7], v[100:103], v[80:83], v[4:7]
    ds_read_b128 v[136:139], v193 offset:6144
    v_mfma_f32_16x16x32_bf16 v[8:11], v[104:107], v[80:83], v[8:11]
    ds_read_b128 v[140:143], v193 offset:7168
    v_mfma_f32_16x16x32_bf16 v[12:15], v[108:111], v[80:83], v[12:15]
    ds_read_b128 v[144:147], v193 offset:8192
    v_mfma_f32_16x16x32_bf16 v[16:19], v[112:115], v[80:83], v[16:19]
    ds_read_b128 v[148:151], v193 offset:9216
    buffer_load_dwordx4 v[80:83], v188, s[4:7], s23 offen sc1
    v_mfma_f32_16x16x32_bf16 v[20:23], v[96:99], v[84:87], v[20:23]
    v_mfma_f32_16x16x32_bf16 v[24:27], v[100:103], v[84:87], v[24:27]
    v_mfma_f32_16x16x32_bf16 v[28:31], v[104:107], v[84:87], v[28:31]
    v_mfma_f32_16x16x32_bf16 v[32:35], v[108:111], v[84:87], v[32:35]
    v_mfma_f32_16x16x32_bf16 v[36:39], v[112:115], v[84:87], v[36:39]
    buffer_load_dwordx4 v[84:87], v189, s[4:7], s23 offen sc1
    v_mfma_f32_16x16x32_bf16 v[40:43], v[96:99], v[88:91], v[40:43]
    v_mfma_f32_16x16x32_bf16 v[44:47], v[100:103], v[88:91], v[44:47]
    v_mfma_f32_16x16x32_bf16 v[48:51], v[104:107], v[88:91], v[48:51]
    v_mfma_f32_16x16x32_bf16 v[52:55], v[108:111], v[88:91], v[52:55]
    v_mfma_f32_16x16x32_bf16 v[56:59], v[112:115], v[88:91], v[56:59]
    buffer_load_dwordx4 v[88:91], v190, s[4:7], s23 offen sc1
    v_mfma_f32_16x16x32_bf16 v[60:63], v[96:99], v[92:95], v[60:63]
    v_mfma_f32_16x16x32_bf16 v[64:67], v[100:103], v[92:95], v[64:67]
    v_mfma_f32_16x16x32_bf16 v[68:71], v[104:107], v[92:95], v[68:71]
    v_mfma_f32_16x16x32_bf16 v[72:75], v[108:111], v[92:95], v[72:75]
    v_mfma_f32_16x16x32_bf16 v[76:79], v[112:115], v[92:95], v[76:79]
    buffer_load_dwordx4 v[92:95], v191, s[4:7], s23 offen sc1
    s_add_u32 s23, s23, 4096
    s_waitcnt vmcnt(8) lgkmcnt(0)
    v_mfma_f32_16x16x32_bf16 v[0:3], v[132:135], v[116:119], v[0:3]
    ds_read_b128 v[168:171], v193 offset:10240
    v_mfma_f32_16x16x32_bf16 v[4:7], v[136:139], v[116:119], v[4:7]
    ds_read_b128 v[172:175], v193 offset:11264
    v_mfma_f32_16x16x32_bf16 v[8:11], v[140:143], v[116:119], v[8:11]
    ds_read_b128 v[176:179], v193 offset:12288
    v_mfma_f32_16x16x32_bf16 v[12:15], v[144:147], v[116:119], v[12:15]
    ds_read_b128 v[180:183], v193 offset:13312
    v_mfma_f32_16x16x32_bf16 v[16:19], v[148:151], v[116:119], v[16:19]
    ds_read_b128 v[184:187], v193 offset:14336
    buffer_load_dwordx4 v[116:119], v188, s[4:7], s23 offen sc1
    v_mfma_f32_16x16x32_bf16 v[20:23], v[132:135], v[120:123], v[20:23]
    v_mfma_f32_16x16x32_bf16 v[24:27], v[136:139], v[120:123], v[24:27]
    v_mfma_f32_16x16x32_bf16 v[28:31], v[140:143], v[120:123], v[28:31]
    v_mfma_f32_16x16x32_bf16 v[32:35], v[144:147], v[120:123], v[32:35]
    v_mfma_f32_16x16x32_bf16 v[36:39], v[148:151], v[120:123], v[36:39]
    buffer_load_dwordx4 v[120:123], v189, s[4:7], s23 offen sc1
    v_mfma_f32_16x16x32_bf16 v[40:43], v[132:135], v[124:127], v[40:43]
    v_mfma_f32_16x16x32_bf16 v[44:47], v[136:139], v[124:127], v[44:47]
    v_mfma_f32_16x16x32_bf16 v[48:51], v[140:143], v[124:127], v[48:51]
    v_mfma_f32_16x16x32_bf16 v[52:55], v[144:147], v[124:127], v[52:55]
    v_mfma_f32_16x16x32_bf16 v[56:59], v[148:151], v[124:127], v[56:59]
    buffer_load_dwordx4 v[124:127], v190, s[4:7], s23 offen sc1
    v_mfma_f32_16x16x32_bf16 v[60:63], v[132:135], v[128:131], v[60:63]
    v_mfma_f32_16x16x32_bf16 v[64:67], v[136:139], v[128:131], v[64:67]
    v_mfma_f32_16x16x32_bf16 v[68:71], v[140:143], v[128:131], v[68:71]
    v_mfma_f32_16x16x32_bf16 v[72:75], v[144:147], v[128:131], v[72:75]
    v_mfma_f32_16x16x32_bf16 v[76:79], v[148:151], v[128:131], v[76:79]
    buffer_load_dwordx4 v[128:131], v191, s[4:7], s23 offen sc1
    s_add_u32 s23, s23, 4096
    s_waitcnt vmcnt(8) lgkmcnt(0)
    s_lshl_b32 s26, s20, 2
    s_add_u32 s26, s26, 147520
    v_mov_b32 v230, s26
    s_mov_b32 s50, 2097152
K_SPINBBHSTREAM_29:
    ds_read_b32 v231, v230
    s_sub_u32 s50, s50, 1
    s_cmp_eq_u32 s50, 0
    s_cbranch_scc1 K_SPINDBBHSTREAM_30
    s_waitcnt lgkmcnt(0)
    v_cmp_gt_u32 vcc, 7, v231
    s_nop 3
    s_cbranch_vccnz K_SPINBBHSTREAM_29
K_SPINDBBHSTREAM_30:
    s_waitcnt lgkmcnt(0)
    v_mfma_f32_16x16x32_bf16 v[0:3], v[168:171], v[152:155], v[0:3]
    ds_read_b128 v[96:99], v193 offset:15360
    v_mfma_f32_16x16x32_bf16 v[4:7], v[172:175], v[152:155], v[4:7]
    ds_read_b128 v[100:103], v193 offset:16384
    v_mfma_f32_16x16x32_bf16 v[8:11], v[176:179], v[152:155], v[8:11]
    ds_read_b128 v[104:107], v193 offset:17408
    v_mfma_f32_16x16x32_bf16 v[12:15], v[180:183], v[152:155], v[12:15]
    ds_read_b128 v[108:111], v193 offset:18432
    v_mfma_f32_16x16x32_bf16 v[16:19], v[184:187], v[152:155], v[16:19]
    ds_read_b128 v[112:115], v193 offset:19456
    buffer_load_dwordx4 v[152:155], v188, s[4:7], s23 offen sc1
    v_mfma_f32_16x16x32_bf16 v[20:23], v[168:171], v[156:159], v[20:23]
    v_mfma_f32_16x16x32_bf16 v[24:27], v[172:175], v[156:159], v[24:27]
    v_mfma_f32_16x16x32_bf16 v[28:31], v[176:179], v[156:159], v[28:31]
    v_mfma_f32_16x16x32_bf16 v[32:35], v[180:183], v[156:159], v[32:35]
    v_mfma_f32_16x16x32_bf16 v[36:39], v[184:187], v[156:159], v[36:39]
    buffer_load_dwordx4 v[156:159], v189, s[4:7], s23 offen sc1
    v_mfma_f32_16x16x32_bf16 v[40:43], v[168:171], v[160:163], v[40:43]
    v_mfma_f32_16x16x32_bf16 v[44:47], v[172:175], v[160:163], v[44:47]
    v_mfma_f32_16x16x32_bf16 v[48:51], v[176:179], v[160:163], v[48:51]
    v_mfma_f32_16x16x32_bf16 v[52:55], v[180:183], v[160:163], v[52:55]
    v_mfma_f32_16x16x32_bf16 v[56:59], v[184:187], v[160:163], v[56:59]
    buffer_load_dwordx4 v[160:163], v190, s[4:7], s23 offen sc1
    v_mfma_f32_16x16x32_bf16 v[60:63], v[168:171], v[164:167], v[60:63]
    v_mfma_f32_16x16x32_bf16 v[64:67], v[172:175], v[164:167], v[64:67]
    v_mfma_f32_16x16x32_bf16 v[68:71], v[176:179], v[164:167], v[68:71]
    v_mfma_f32_16x16x32_bf16 v[72:75], v[180:183], v[164:167], v[72:75]
    v_mfma_f32_16x16x32_bf16 v[76:79], v[184:187], v[164:167], v[76:79]
    buffer_load_dwordx4 v[164:167], v191, s[4:7], s23 offen sc1
    s_add_u32 s23, s23, 4096
    s_waitcnt vmcnt(8) lgkmcnt(0)
    v_mfma_f32_16x16x32_bf16 v[0:3], v[96:99], v[80:83], v[0:3]
    ds_read_b128 v[132:135], v193 offset:20480
    v_mfma_f32_16x16x32_bf16 v[4:7], v[100:103], v[80:83], v[4:7]
    ds_read_b128 v[136:139], v193 offset:21504
    v_mfma_f32_16x16x32_bf16 v[8:11], v[104:107], v[80:83], v[8:11]
    ds_read_b128 v[140:143], v193 offset:22528
    v_mfma_f32_16x16x32_bf16 v[12:15], v[108:111], v[80:83], v[12:15]
    ds_read_b128 v[144:147], v193 offset:23552
    v_mfma_f32_16x16x32_bf16 v[16:19], v[112:115], v[80:83], v[16:19]
    ds_read_b128 v[148:151], v193 offset:24576
    buffer_load_dwordx4 v[80:83], v188, s[4:7], s23 offen sc1
    v_mfma_f32_16x16x32_bf16 v[20:23], v[96:99], v[84:87], v[20:23]
    v_mfma_f32_16x16x32_bf16 v[24:27], v[100:103], v[84:87], v[24:27]
    v_mfma_f32_16x16x32_bf16 v[28:31], v[104:107], v[84:87], v[28:31]
    v_mfma_f32_16x16x32_bf16 v[32:35], v[108:111], v[84:87], v[32:35]
    v_mfma_f32_16x16x32_bf16 v[36:39], v[112:115], v[84:87], v[36:39]
    buffer_load_dwordx4 v[84:87], v189, s[4:7], s23 offen sc1
    v_mfma_f32_16x16x32_bf16 v[40:43], v[96:99], v[88:91], v[40:43]
    v_mfma_f32_16x16x32_bf16 v[44:47], v[100:103], v[88:91], v[44:47]
    v_mfma_f32_16x16x32_bf16 v[48:51], v[104:107], v[88:91], v[48:51]
    v_mfma_f32_16x16x32_bf16 v[52:55], v[108:111], v[88:91], v[52:55]
    v_mfma_f32_16x16x32_bf16 v[56:59], v[112:115], v[88:91], v[56:59]
    buffer_load_dwordx4 v[88:91], v190, s[4:7], s23 offen sc1
    v_mfma_f32_16x16x32_bf16 v[60:63], v[96:99], v[92:95], v[60:63]
    v_mfma_f32_16x16x32_bf16 v[64:67], v[100:103], v[92:95], v[64:67]
    v_mfma_f32_16x16x32_bf16 v[68:71], v[104:107], v[92:95], v[68:71]
    v_mfma_f32_16x16x32_bf16 v[72:75], v[108:111], v[92:95], v[72:75]
    v_mfma_f32_16x16x32_bf16 v[76:79], v[112:115], v[92:95], v[76:79]
    buffer_load_dwordx4 v[92:95], v191, s[4:7], s23 offen sc1
    s_add_u32 s23, s23, 4096
    s_waitcnt vmcnt(8) lgkmcnt(0)
    v_mfma_f32_16x16x32_bf16 v[0:3], v[132:135], v[116:119], v[0:3]
    ds_read_b128 v[168:171], v193 offset:25600
    v_mfma_f32_16x16x32_bf16 v[4:7], v[136:139], v[116:119], v[4:7]
    ds_read_b128 v[172:175], v193 offset:26624
    v_mfma_f32_16x16x32_bf16 v[8:11], v[140:143], v[116:119], v[8:11]
    ds_read_b128 v[176:179], v193 offset:27648
    v_mfma_f32_16x16x32_bf16 v[12:15], v[144:147], v[116:119], v[12:15]
    ds_read_b128 v[180:183], v193 offset:28672
    v_mfma_f32_16x16x32_bf16 v[16:19], v[148:151], v[116:119], v[16:19]
    ds_read_b128 v[184:187], v193 offset:29696
    buffer_load_dwordx4 v[116:119], v188, s[4:7], s23 offen sc1
    v_mfma_f32_16x16x32_bf16 v[20:23], v[132:135], v[120:123], v[20:23]
    v_mfma_f32_16x16x32_bf16 v[24:27], v[136:139], v[120:123], v[24:27]
    v_mfma_f32_16x16x32_bf16 v[28:31], v[140:143], v[120:123], v[28:31]
    v_mfma_f32_16x16x32_bf16 v[32:35], v[144:147], v[120:123], v[32:35]
    v_mfma_f32_16x16x32_bf16 v[36:39], v[148:151], v[120:123], v[36:39]
    buffer_load_dwordx4 v[120:123], v189, s[4:7], s23 offen sc1
    v_mfma_f32_16x16x32_bf16 v[40:43], v[132:135], v[124:127], v[40:43]
    v_mfma_f32_16x16x32_bf16 v[44:47], v[136:139], v[124:127], v[44:47]
    v_mfma_f32_16x16x32_bf16 v[48:51], v[140:143], v[124:127], v[48:51]
    v_mfma_f32_16x16x32_bf16 v[52:55], v[144:147], v[124:127], v[52:55]
    v_mfma_f32_16x16x32_bf16 v[56:59], v[148:151], v[124:127], v[56:59]
    buffer_load_dwordx4 v[124:127], v190, s[4:7], s23 offen sc1
    v_mfma_f32_16x16x32_bf16 v[60:63], v[132:135], v[128:131], v[60:63]
    buffer_load_dwordx4 v[132:135], v192, s[4:7], s24 offen sc1
    v_mfma_f32_16x16x32_bf16 v[64:67], v[136:139], v[128:131], v[64:67]
    buffer_load_dwordx4 v[136:139], v192, s[4:7], s24 offen offset:1024 sc1
    v_mfma_f32_16x16x32_bf16 v[68:71], v[140:143], v[128:131], v[68:71]
    buffer_load_dwordx4 v[140:143], v192, s[4:7], s24 offen offset:2048 sc1
    v_mfma_f32_16x16x32_bf16 v[72:75], v[144:147], v[128:131], v[72:75]
    buffer_load_dwordx4 v[144:147], v192, s[4:7], s24 offen offset:3072 sc1
    v_mfma_f32_16x16x32_bf16 v[76:79], v[148:151], v[128:131], v[76:79]
    buffer_load_dwordx4 v[128:131], v191, s[4:7], s23 offen sc1
    buffer_load_dwordx4 v[148:151], v241, s[4:7], s24 offen sc1
    s_add_u32 s23, s23, 4096
    s_add_u32 s24, s24, 40960
    s_waitcnt vmcnt(13) lgkmcnt(0)
    v_mfma_f32_16x16x32_bf16 v[0:3], v[168:171], v[152:155], v[0:3]
    ds_read_b128 v[96:99], v193 offset:30720
    v_mfma_f32_16x16x32_bf16 v[4:7], v[172:175], v[152:155], v[4:7]
    ds_read_b128 v[100:103], v193 offset:31744
    v_mfma_f32_16x16x32_bf16 v[8:11], v[176:179], v[152:155], v[8:11]
    ds_read_b128 v[104:107], v193 offset:32768
    v_mfma_f32_16x16x32_bf16 v[12:15], v[180:183], v[152:155], v[12:15]
    ds_read_b128 v[108:111], v193 offset:33792
    v_mfma_f32_16x16x32_bf16 v[16:19], v[184:187], v[152:155], v[16:19]
    ds_read_b128 v[112:115], v193 offset:34816
    buffer_load_dwordx4 v[152:155], v188, s[4:7], s23 offen sc1
    v_mfma_f32_16x16x32_bf16 v[20:23], v[168:171], v[156:159], v[20:23]
    v_mfma_f32_16x16x32_bf16 v[24:27], v[172:175], v[156:159], v[24:27]
    v_mfma_f32_16x16x32_bf16 v[28:31], v[176:179], v[156:159], v[28:31]
    v_mfma_f32_16x16x32_bf16 v[32:35], v[180:183], v[156:159], v[32:35]
    v_mfma_f32_16x16x32_bf16 v[36:39], v[184:187], v[156:159], v[36:39]
    buffer_load_dwordx4 v[156:159], v189, s[4:7], s23 offen sc1
    v_mfma_f32_16x16x32_bf16 v[40:43], v[168:171], v[160:163], v[40:43]
    v_mfma_f32_16x16x32_bf16 v[44:47], v[172:175], v[160:163], v[44:47]
    v_mfma_f32_16x16x32_bf16 v[48:51], v[176:179], v[160:163], v[48:51]
    v_mfma_f32_16x16x32_bf16 v[52:55], v[180:183], v[160:163], v[52:55]
    v_mfma_f32_16x16x32_bf16 v[56:59], v[184:187], v[160:163], v[56:59]
    buffer_load_dwordx4 v[160:163], v190, s[4:7], s23 offen sc1
    v_mfma_f32_16x16x32_bf16 v[60:63], v[168:171], v[164:167], v[60:63]
    buffer_load_dwordx4 v[168:171], v192, s[4:7], s24 offen sc1
    v_mfma_f32_16x16x32_bf16 v[64:67], v[172:175], v[164:167], v[64:67]
    buffer_load_dwordx4 v[172:175], v192, s[4:7], s24 offen offset:1024 sc1
    v_mfma_f32_16x16x32_bf16 v[68:71], v[176:179], v[164:167], v[68:71]
    buffer_load_dwordx4 v[176:179], v192, s[4:7], s24 offen offset:2048 sc1
    v_mfma_f32_16x16x32_bf16 v[72:75], v[180:183], v[164:167], v[72:75]
    buffer_load_dwordx4 v[180:183], v192, s[4:7], s24 offen offset:3072 sc1
    v_mfma_f32_16x16x32_bf16 v[76:79], v[184:187], v[164:167], v[76:79]
    buffer_load_dwordx4 v[164:167], v191, s[4:7], s23 offen sc1
    buffer_load_dwordx4 v[184:187], v241, s[4:7], s24 offen sc1
    s_add_u32 s23, s23, 4096
    s_add_u32 s24, s24, 40960
    s_waitcnt vmcnt(18) lgkmcnt(0)
    v_mfma_f32_16x16x32_bf16 v[0:3], v[96:99], v[80:83], v[0:3]
    v_mfma_f32_16x16x32_bf16 v[4:7], v[100:103], v[80:83], v[4:7]
    v_mfma_f32_16x16x32_bf16 v[8:11], v[104:107], v[80:83], v[8:11]
    v_mfma_f32_16x16x32_bf16 v[12:15], v[108:111], v[80:83], v[12:15]
    v_mfma_f32_16x16x32_bf16 v[16:19], v[112:115], v[80:83], v[16:19]
    buffer_load_dwordx4 v[80:83], v188, s[4:7], s23 offen sc1
    v_mfma_f32_16x16x32_bf16 v[20:23], v[96:99], v[84:87], v[20:23]
    v_mfma_f32_16x16x32_bf16 v[24:27], v[100:103], v[84:87], v[24:27]
    v_mfma_f32_16x16x32_bf16 v[28:31], v[104:107], v[84:87], v[28:31]
    v_mfma_f32_16x16x32_bf16 v[32:35], v[108:111], v[84:87], v[32:35]
    v_mfma_f32_16x16x32_bf16 v[36:39], v[112:115], v[84:87], v[36:39]
    buffer_load_dwordx4 v[84:87], v189, s[4:7], s23 offen sc1
    v_mfma_f32_16x16x32_bf16 v[40:43], v[96:99], v[88:91], v[40:43]
    v_mfma_f32_16x16x32_bf16 v[44:47], v[100:103], v[88:91], v[44:47]
    v_mfma_f32_16x16x32_bf16 v[48:51], v[104:107], v[88:91], v[48:51]
    v_mfma_f32_16x16x32_bf16 v[52:55], v[108:111], v[88:91], v[52:55]
    v_mfma_f32_16x16x32_bf16 v[56:59], v[112:115], v[88:91], v[56:59]
    buffer_load_dwordx4 v[88:91], v190, s[4:7], s23 offen sc1
    v_mfma_f32_16x16x32_bf16 v[60:63], v[96:99], v[92:95], v[60:63]
    buffer_load_dwordx4 v[96:99], v192, s[4:7], s24 offen sc1
    v_mfma_f32_16x16x32_bf16 v[64:67], v[100:103], v[92:95], v[64:67]
    buffer_load_dwordx4 v[100:103], v192, s[4:7], s24 offen offset:1024 sc1
    v_mfma_f32_16x16x32_bf16 v[68:71], v[104:107], v[92:95], v[68:71]
    buffer_load_dwordx4 v[104:107], v192, s[4:7], s24 offen offset:2048 sc1
    v_mfma_f32_16x16x32_bf16 v[72:75], v[108:111], v[92:95], v[72:75]
    buffer_load_dwordx4 v[108:111], v192, s[4:7], s24 offen offset:3072 sc1
    v_mfma_f32_16x16x32_bf16 v[76:79], v[112:115], v[92:95], v[76:79]
    buffer_load_dwordx4 v[92:95], v191, s[4:7], s23 offen sc1
    buffer_load_dwordx4 v[112:115], v241, s[4:7], s24 offen sc1
    s_add_u32 s23, s23, 4096
    s_add_u32 s24, s24, 40960
    s_waitcnt vmcnt(18) lgkmcnt(0)
    v_mfma_f32_16x16x32_bf16 v[0:3], v[132:135], v[116:119], v[0:3]
    v_mfma_f32_16x16x32_bf16 v[4:7], v[136:139], v[116:119], v[4:7]
    v_mfma_f32_16x16x32_bf16 v[8:11], v[140:143], v[116:119], v[8:11]
    v_mfma_f32_16x16x32_bf16 v[12:15], v[144:147], v[116:119], v[12:15]
    v_mfma_f32_16x16x32_bf16 v[16:19], v[148:151], v[116:119], v[16:19]
    buffer_load_dwordx4 v[116:119], v188, s[4:7], s23 offen sc1
    v_mfma_f32_16x16x32_bf16 v[20:23], v[132:135], v[120:123], v[20:23]
    v_mfma_f32_16x16x32_bf16 v[24:27], v[136:139], v[120:123], v[24:27]
    v_mfma_f32_16x16x32_bf16 v[28:31], v[140:143], v[120:123], v[28:31]
    v_mfma_f32_16x16x32_bf16 v[32:35], v[144:147], v[120:123], v[32:35]
    v_mfma_f32_16x16x32_bf16 v[36:39], v[148:151], v[120:123], v[36:39]
    buffer_load_dwordx4 v[120:123], v189, s[4:7], s23 offen sc1
    v_mfma_f32_16x16x32_bf16 v[40:43], v[132:135], v[124:127], v[40:43]
    v_mfma_f32_16x16x32_bf16 v[44:47], v[136:139], v[124:127], v[44:47]
    v_mfma_f32_16x16x32_bf16 v[48:51], v[140:143], v[124:127], v[48:51]
    v_mfma_f32_16x16x32_bf16 v[52:55], v[144:147], v[124:127], v[52:55]
    v_mfma_f32_16x16x32_bf16 v[56:59], v[148:151], v[124:127], v[56:59]
    buffer_load_dwordx4 v[124:127], v190, s[4:7], s23 offen sc1
    v_mfma_f32_16x16x32_bf16 v[60:63], v[132:135], v[128:131], v[60:63]
    buffer_load_dwordx4 v[132:135], v192, s[4:7], s24 offen sc1
    v_mfma_f32_16x16x32_bf16 v[64:67], v[136:139], v[128:131], v[64:67]
    buffer_load_dwordx4 v[136:139], v192, s[4:7], s24 offen offset:1024 sc1
    v_mfma_f32_16x16x32_bf16 v[68:71], v[140:143], v[128:131], v[68:71]
    buffer_load_dwordx4 v[140:143], v192, s[4:7], s24 offen offset:2048 sc1
    v_mfma_f32_16x16x32_bf16 v[72:75], v[144:147], v[128:131], v[72:75]
    buffer_load_dwordx4 v[144:147], v192, s[4:7], s24 offen offset:3072 sc1
    v_mfma_f32_16x16x32_bf16 v[76:79], v[148:151], v[128:131], v[76:79]
    buffer_load_dwordx4 v[128:131], v191, s[4:7], s23 offen sc1
    buffer_load_dwordx4 v[148:151], v241, s[4:7], s24 offen sc1
    s_add_u32 s23, s23, 4096
    s_add_u32 s24, s24, 40960
    s_waitcnt vmcnt(18) lgkmcnt(0)
    v_mfma_f32_16x16x32_bf16 v[0:3], v[168:171], v[152:155], v[0:3]
    v_mfma_f32_16x16x32_bf16 v[4:7], v[172:175], v[152:155], v[4:7]
    v_mfma_f32_16x16x32_bf16 v[8:11], v[176:179], v[152:155], v[8:11]
    v_mfma_f32_16x16x32_bf16 v[12:15], v[180:183], v[152:155], v[12:15]
    v_mfma_f32_16x16x32_bf16 v[16:19], v[184:187], v[152:155], v[16:19]
    buffer_load_dwordx4 v[152:155], v188, s[4:7], s23 offen sc1
    v_mfma_f32_16x16x32_bf16 v[20:23], v[168:171], v[156:159], v[20:23]
    v_mfma_f32_16x16x32_bf16 v[24:27], v[172:175], v[156:159], v[24:27]
    v_mfma_f32_16x16x32_bf16 v[28:31], v[176:179], v[156:159], v[28:31]
    v_mfma_f32_16x16x32_bf16 v[32:35], v[180:183], v[156:159], v[32:35]
    v_mfma_f32_16x16x32_bf16 v[36:39], v[184:187], v[156:159], v[36:39]
    buffer_load_dwordx4 v[156:159], v189, s[4:7], s23 offen sc1
    v_mfma_f32_16x16x32_bf16 v[40:43], v[168:171], v[160:163], v[40:43]
    v_mfma_f32_16x16x32_bf16 v[44:47], v[172:175], v[160:163], v[44:47]
    v_mfma_f32_16x16x32_bf16 v[48:51], v[176:179], v[160:163], v[48:51]
    v_mfma_f32_16x16x32_bf16 v[52:55], v[180:183], v[160:163], v[52:55]
    v_mfma_f32_16x16x32_bf16 v[56:59], v[184:187], v[160:163], v[56:59]
    buffer_load_dwordx4 v[160:163], v190, s[4:7], s23 offen sc1
    v_mfma_f32_16x16x32_bf16 v[60:63], v[168:171], v[164:167], v[60:63]
    buffer_load_dwordx4 v[168:171], v192, s[4:7], s24 offen sc1
    v_mfma_f32_16x16x32_bf16 v[64:67], v[172:175], v[164:167], v[64:67]
    buffer_load_dwordx4 v[172:175], v192, s[4:7], s24 offen offset:1024 sc1
    v_mfma_f32_16x16x32_bf16 v[68:71], v[176:179], v[164:167], v[68:71]
    buffer_load_dwordx4 v[176:179], v192, s[4:7], s24 offen offset:2048 sc1
    v_mfma_f32_16x16x32_bf16 v[72:75], v[180:183], v[164:167], v[72:75]
    buffer_load_dwordx4 v[180:183], v192, s[4:7], s24 offen offset:3072 sc1
    v_mfma_f32_16x16x32_bf16 v[76:79], v[184:187], v[164:167], v[76:79]
    buffer_load_dwordx4 v[164:167], v191, s[4:7], s23 offen sc1
    buffer_load_dwordx4 v[184:187], v241, s[4:7], s24 offen sc1
    s_add_u32 s23, s23, 4096
    s_add_u32 s24, s24, 40960
    s_waitcnt vmcnt(18) lgkmcnt(0)
    v_mfma_f32_16x16x32_bf16 v[0:3], v[96:99], v[80:83], v[0:3]
    v_mfma_f32_16x16x32_bf16 v[4:7], v[100:103], v[80:83], v[4:7]
    v_mfma_f32_16x16x32_bf16 v[8:11], v[104:107], v[80:83], v[8:11]
    v_mfma_f32_16x16x32_bf16 v[12:15], v[108:111], v[80:83], v[12:15]
    v_mfma_f32_16x16x32_bf16 v[16:19], v[112:115], v[80:83], v[16:19]
    buffer_load_dwordx4 v[80:83], v188, s[4:7], s23 offen sc1
    v_mfma_f32_16x16x32_bf16 v[20:23], v[96:99], v[84:87], v[20:23]
    v_mfma_f32_16x16x32_bf16 v[24:27], v[100:103], v[84:87], v[24:27]
    v_mfma_f32_16x16x32_bf16 v[28:31], v[104:107], v[84:87], v[28:31]
    v_mfma_f32_16x16x32_bf16 v[32:35], v[108:111], v[84:87], v[32:35]
    v_mfma_f32_16x16x32_bf16 v[36:39], v[112:115], v[84:87], v[36:39]
    buffer_load_dwordx4 v[84:87], v189, s[4:7], s23 offen sc1
    v_mfma_f32_16x16x32_bf16 v[40:43], v[96:99], v[88:91], v[40:43]
    v_mfma_f32_16x16x32_bf16 v[44:47], v[100:103], v[88:91], v[44:47]
    v_mfma_f32_16x16x32_bf16 v[48:51], v[104:107], v[88:91], v[48:51]
    v_mfma_f32_16x16x32_bf16 v[52:55], v[108:111], v[88:91], v[52:55]
    v_mfma_f32_16x16x32_bf16 v[56:59], v[112:115], v[88:91], v[56:59]
    buffer_load_dwordx4 v[88:91], v190, s[4:7], s23 offen sc1
    v_mfma_f32_16x16x32_bf16 v[60:63], v[96:99], v[92:95], v[60:63]
    buffer_load_dwordx4 v[96:99], v192, s[4:7], s24 offen sc1
    v_mfma_f32_16x16x32_bf16 v[64:67], v[100:103], v[92:95], v[64:67]
    buffer_load_dwordx4 v[100:103], v192, s[4:7], s24 offen offset:1024 sc1
    v_mfma_f32_16x16x32_bf16 v[68:71], v[104:107], v[92:95], v[68:71]
    buffer_load_dwordx4 v[104:107], v192, s[4:7], s24 offen offset:2048 sc1
    v_mfma_f32_16x16x32_bf16 v[72:75], v[108:111], v[92:95], v[72:75]
    buffer_load_dwordx4 v[108:111], v192, s[4:7], s24 offen offset:3072 sc1
    v_mfma_f32_16x16x32_bf16 v[76:79], v[112:115], v[92:95], v[76:79]
    buffer_load_dwordx4 v[92:95], v191, s[4:7], s23 offen sc1
    buffer_load_dwordx4 v[112:115], v241, s[4:7], s24 offen sc1
    s_add_u32 s23, s23, 4096
    s_add_u32 s24, s24, 40960
    s_waitcnt vmcnt(18) lgkmcnt(0)
    v_mfma_f32_16x16x32_bf16 v[0:3], v[132:135], v[116:119], v[0:3]
    v_mfma_f32_16x16x32_bf16 v[4:7], v[136:139], v[116:119], v[4:7]
    v_mfma_f32_16x16x32_bf16 v[8:11], v[140:143], v[116:119], v[8:11]
    v_mfma_f32_16x16x32_bf16 v[12:15], v[144:147], v[116:119], v[12:15]
    v_mfma_f32_16x16x32_bf16 v[16:19], v[148:151], v[116:119], v[16:19]
    buffer_load_dwordx4 v[116:119], v188, s[4:7], s23 offen sc1
    v_mfma_f32_16x16x32_bf16 v[20:23], v[132:135], v[120:123], v[20:23]
    v_mfma_f32_16x16x32_bf16 v[24:27], v[136:139], v[120:123], v[24:27]
    v_mfma_f32_16x16x32_bf16 v[28:31], v[140:143], v[120:123], v[28:31]
    v_mfma_f32_16x16x32_bf16 v[32:35], v[144:147], v[120:123], v[32:35]
    v_mfma_f32_16x16x32_bf16 v[36:39], v[148:151], v[120:123], v[36:39]
    buffer_load_dwordx4 v[120:123], v189, s[4:7], s23 offen sc1
    v_mfma_f32_16x16x32_bf16 v[40:43], v[132:135], v[124:127], v[40:43]
    v_mfma_f32_16x16x32_bf16 v[44:47], v[136:139], v[124:127], v[44:47]
    v_mfma_f32_16x16x32_bf16 v[48:51], v[140:143], v[124:127], v[48:51]
    v_mfma_f32_16x16x32_bf16 v[52:55], v[144:147], v[124:127], v[52:55]
    v_mfma_f32_16x16x32_bf16 v[56:59], v[148:151], v[124:127], v[56:59]
    buffer_load_dwordx4 v[124:127], v190, s[4:7], s23 offen sc1
    v_mfma_f32_16x16x32_bf16 v[60:63], v[132:135], v[128:131], v[60:63]
    buffer_load_dwordx4 v[132:135], v192, s[4:7], s24 offen sc1
    v_mfma_f32_16x16x32_bf16 v[64:67], v[136:139], v[128:131], v[64:67]
    buffer_load_dwordx4 v[136:139], v192, s[4:7], s24 offen offset:1024 sc1
    v_mfma_f32_16x16x32_bf16 v[68:71], v[140:143], v[128:131], v[68:71]
    buffer_load_dwordx4 v[140:143], v192, s[4:7], s24 offen offset:2048 sc1
    v_mfma_f32_16x16x32_bf16 v[72:75], v[144:147], v[128:131], v[72:75]
    buffer_load_dwordx4 v[144:147], v192, s[4:7], s24 offen offset:3072 sc1
    v_mfma_f32_16x16x32_bf16 v[76:79], v[148:151], v[128:131], v[76:79]
    buffer_load_dwordx4 v[128:131], v191, s[4:7], s23 offen sc1
    buffer_load_dwordx4 v[148:151], v241, s[4:7], s24 offen sc1
    s_add_u32 s23, s23, 4096
    s_add_u32 s24, s24, 40960
    s_waitcnt vmcnt(18) lgkmcnt(0)
    v_mov_b32 v230, 147484
    s_mov_b32 s50, 2097152
K_SPINGHSTREAM_31:
    ds_read_b32 v231, v230
    s_sub_u32 s50, s50, 1
    s_cmp_eq_u32 s50, 0
    s_cbranch_scc1 K_SPINDGHSTREAM_32
    s_waitcnt lgkmcnt(0)
    v_cmp_ne_u32 vcc, 1, v231
    s_nop 3
    s_cbranch_vccnz K_SPINGHSTREAM_31
K_SPINDGHSTREAM_32:
    s_waitcnt lgkmcnt(0)
    buffer_load_dwordx2 v[194:195], v227, s[4:7], 0 offen sc1
    v_mfma_f32_16x16x32_bf16 v[0:3], v[168:171], v[152:155], v[0:3]
    v_mfma_f32_16x16x32_bf16 v[4:7], v[172:175], v[152:155], v[4:7]
    v_mfma_f32_16x16x32_bf16 v[8:11], v[176:179], v[152:155], v[8:11]
    v_mfma_f32_16x16x32_bf16 v[12:15], v[180:183], v[152:155], v[12:15]
    v_mfma_f32_16x16x32_bf16 v[16:19], v[184:187], v[152:155], v[16:19]
    buffer_load_dwordx4 v[152:155], v188, s[4:7], s23 offen sc1
    v_mfma_f32_16x16x32_bf16 v[20:23], v[168:171], v[156:159], v[20:23]
    v_mfma_f32_16x16x32_bf16 v[24:27], v[172:175], v[156:159], v[24:27]
    v_mfma_f32_16x16x32_bf16 v[28:31], v[176:179], v[156:159], v[28:31]
    v_mfma_f32_16x16x32_bf16 v[32:35], v[180:183], v[156:159], v[32:35]
    v_mfma_f32_16x16x32_bf16 v[36:39], v[184:187], v[156:159], v[36:39]
    buffer_load_dwordx4 v[156:159], v189, s[4:7], s23 offen sc1
    v_mfma_f32_16x16x32_bf16 v[40:43], v[168:171], v[160:163], v[40:43]
    v_mfma_f32_16x16x32_bf16 v[44:47], v[172:175], v[160:163], v[44:47]
    v_mfma_f32_16x16x32_bf16 v[48:51], v[176:179], v[160:163], v[48:51]
    v_mfma_f32_16x16x32_bf16 v[52:55], v[180:183], v[160:163], v[52:55]
    v_mfma_f32_16x16x32_bf16 v[56:59], v[184:187], v[160:163], v[56:59]
    buffer_load_dwordx4 v[160:163], v190, s[4:7], s23 offen sc1
    v_mfma_f32_16x16x32_bf16 v[60:63], v[168:171], v[164:167], v[60:63]
    buffer_load_dwordx4 v[168:171], v192, s[4:7], s24 offen sc1
    v_mfma_f32_16x16x32_bf16 v[64:67], v[172:175], v[164:167], v[64:67]
    buffer_load_dwordx4 v[172:175], v192, s[4:7], s24 offen offset:1024 sc1
    v_mfma_f32_16x16x32_bf16 v[68:71], v[176:179], v[164:167], v[68:71]
    buffer_load_dwordx4 v[176:179], v192, s[4:7], s24 offen offset:2048 sc1
    v_mfma_f32_16x16x32_bf16 v[72:75], v[180:183], v[164:167], v[72:75]
    buffer_load_dwordx4 v[180:183], v192, s[4:7], s24 offen offset:3072 sc1
    v_mfma_f32_16x16x32_bf16 v[76:79], v[184:187], v[164:167], v[76:79]
    buffer_load_dwordx4 v[164:167], v191, s[4:7], s23 offen sc1
    buffer_load_dwordx4 v[184:187], v241, s[4:7], s24 offen sc1
    s_add_u32 s23, s23, 4096
    s_add_u32 s24, s24, 40960
    s_waitcnt vmcnt(19) lgkmcnt(0)
    v_mfma_f32_16x16x32_bf16 v[0:3], v[96:99], v[80:83], v[0:3]
    v_mfma_f32_16x16x32_bf16 v[4:7], v[100:103], v[80:83], v[4:7]
    v_mfma_f32_16x16x32_bf16 v[8:11], v[104:107], v[80:83], v[8:11]
    v_mfma_f32_16x16x32_bf16 v[12:15], v[108:111], v[80:83], v[12:15]
    v_mfma_f32_16x16x32_bf16 v[16:19], v[112:115], v[80:83], v[16:19]
    buffer_load_dwordx4 v[80:83], v188, s[4:7], s23 offen sc1
    v_mfma_f32_16x16x32_bf16 v[20:23], v[96:99], v[84:87], v[20:23]
    v_mfma_f32_16x16x32_bf16 v[24:27], v[100:103], v[84:87], v[24:27]
    v_mfma_f32_16x16x32_bf16 v[28:31], v[104:107], v[84:87], v[28:31]
    v_mfma_f32_16x16x32_bf16 v[32:35], v[108:111], v[84:87], v[32:35]
    v_mfma_f32_16x16x32_bf16 v[36:39], v[112:115], v[84:87], v[36:39]
    buffer_load_dwordx4 v[84:87], v189, s[4:7], s23 offen sc1
    v_mfma_f32_16x16x32_bf16 v[40:43], v[96:99], v[88:91], v[40:43]
    v_mfma_f32_16x16x32_bf16 v[44:47], v[100:103], v[88:91], v[44:47]
    v_mfma_f32_16x16x32_bf16 v[48:51], v[104:107], v[88:91], v[48:51]
    v_mfma_f32_16x16x32_bf16 v[52:55], v[108:111], v[88:91], v[52:55]
    v_mfma_f32_16x16x32_bf16 v[56:59], v[112:115], v[88:91], v[56:59]
    buffer_load_dwordx4 v[88:91], v190, s[4:7], s23 offen sc1
    v_mfma_f32_16x16x32_bf16 v[60:63], v[96:99], v[92:95], v[60:63]
    buffer_load_dwordx4 v[96:99], v192, s[4:7], s24 offen sc1
    v_mfma_f32_16x16x32_bf16 v[64:67], v[100:103], v[92:95], v[64:67]
    buffer_load_dwordx4 v[100:103], v192, s[4:7], s24 offen offset:1024 sc1
    v_mfma_f32_16x16x32_bf16 v[68:71], v[104:107], v[92:95], v[68:71]
    buffer_load_dwordx4 v[104:107], v192, s[4:7], s24 offen offset:2048 sc1
    v_mfma_f32_16x16x32_bf16 v[72:75], v[108:111], v[92:95], v[72:75]
    buffer_load_dwordx4 v[108:111], v192, s[4:7], s24 offen offset:3072 sc1
    v_mfma_f32_16x16x32_bf16 v[76:79], v[112:115], v[92:95], v[76:79]
    buffer_load_dwordx4 v[92:95], v191, s[4:7], s23 offen sc1
    buffer_load_dwordx4 v[112:115], v241, s[4:7], s24 offen sc1
    s_add_u32 s23, s23, 4096
    s_add_u32 s24, s24, 40960
    s_waitcnt vmcnt(19) lgkmcnt(0)
    v_mfma_f32_16x16x32_bf16 v[0:3], v[132:135], v[116:119], v[0:3]
    v_mfma_f32_16x16x32_bf16 v[4:7], v[136:139], v[116:119], v[4:7]
    v_mfma_f32_16x16x32_bf16 v[8:11], v[140:143], v[116:119], v[8:11]
    v_mfma_f32_16x16x32_bf16 v[12:15], v[144:147], v[116:119], v[12:15]
    v_mfma_f32_16x16x32_bf16 v[16:19], v[148:151], v[116:119], v[16:19]
    buffer_load_dwordx4 v[116:119], v188, s[4:7], s23 offen sc1
    v_mfma_f32_16x16x32_bf16 v[20:23], v[132:135], v[120:123], v[20:23]
    v_mfma_f32_16x16x32_bf16 v[24:27], v[136:139], v[120:123], v[24:27]
    v_mfma_f32_16x16x32_bf16 v[28:31], v[140:143], v[120:123], v[28:31]
    v_mfma_f32_16x16x32_bf16 v[32:35], v[144:147], v[120:123], v[32:35]
    v_mfma_f32_16x16x32_bf16 v[36:39], v[148:151], v[120:123], v[36:39]
    buffer_load_dwordx4 v[120:123], v189, s[4:7], s23 offen sc1
    v_mfma_f32_16x16x32_bf16 v[40:43], v[132:135], v[124:127], v[40:43]
    v_mfma_f32_16x16x32_bf16 v[44:47], v[136:139], v[124:127], v[44:47]
    v_mfma_f32_16x16x32_bf16 v[48:51], v[140:143], v[124:127], v[48:51]
    v_mfma_f32_16x16x32_bf16 v[52:55], v[144:147], v[124:127], v[52:55]
    v_mfma_f32_16x16x32_bf16 v[56:59], v[148:151], v[124:127], v[56:59]
    buffer_load_dwordx4 v[124:127], v190, s[4:7], s23 offen sc1
    v_mfma_f32_16x16x32_bf16 v[60:63], v[132:135], v[128:131], v[60:63]
    buffer_load_dwordx4 v[132:135], v192, s[4:7], s24 offen sc1
    v_mfma_f32_16x16x32_bf16 v[64:67], v[136:139], v[128:131], v[64:67]
    buffer_load_dwordx4 v[136:139], v192, s[4:7], s24 offen offset:1024 sc1
    v_mfma_f32_16x16x32_bf16 v[68:71], v[140:143], v[128:131], v[68:71]
    buffer_load_dwordx4 v[140:143], v192, s[4:7], s24 offen offset:2048 sc1
    v_mfma_f32_16x16x32_bf16 v[72:75], v[144:147], v[128:131], v[72:75]
    buffer_load_dwordx4 v[144:147], v192, s[4:7], s24 offen offset:3072 sc1
    v_mfma_f32_16x16x32_bf16 v[76:79], v[148:151], v[128:131], v[76:79]
    buffer_load_dwordx4 v[128:131], v191, s[4:7], s23 offen sc1
    buffer_load_dwordx4 v[148:151], v241, s[4:7], s24 offen sc1
    s_add_u32 s23, s23, 4096
    s_add_u32 s24, s24, 40960
    s_waitcnt vmcnt(18) lgkmcnt(0)
    v_mfma_f32_16x16x32_bf16 v[0:3], v[168:171], v[152:155], v[0:3]
    v_mfma_f32_16x16x32_bf16 v[4:7], v[172:175], v[152:155], v[4:7]
    v_mfma_f32_16x16x32_bf16 v[8:11], v[176:179], v[152:155], v[8:11]
    v_mfma_f32_16x16x32_bf16 v[12:15], v[180:183], v[152:155], v[12:15]
    v_mfma_f32_16x16x32_bf16 v[16:19], v[184:187], v[152:155], v[16:19]
    buffer_load_dwordx4 v[152:155], v188, s[4:7], s23 offen sc1
    v_mfma_f32_16x16x32_bf16 v[20:23], v[168:171], v[156:159], v[20:23]
    v_mfma_f32_16x16x32_bf16 v[24:27], v[172:175], v[156:159], v[24:27]
    v_mfma_f32_16x16x32_bf16 v[28:31], v[176:179], v[156:159], v[28:31]
    v_mfma_f32_16x16x32_bf16 v[32:35], v[180:183], v[156:159], v[32:35]
    v_mfma_f32_16x16x32_bf16 v[36:39], v[184:187], v[156:159], v[36:39]
    buffer_load_dwordx4 v[156:159], v189, s[4:7], s23 offen sc1
    v_mfma_f32_16x16x32_bf16 v[40:43], v[168:171], v[160:163], v[40:43]
    v_mfma_f32_16x16x32_bf16 v[44:47], v[172:175], v[160:163], v[44:47]
    v_mfma_f32_16x16x32_bf16 v[48:51], v[176:179], v[160:163], v[48:51]
    v_mfma_f32_16x16x32_bf16 v[52:55], v[180:183], v[160:163], v[52:55]
    v_mfma_f32_16x16x32_bf16 v[56:59], v[184:187], v[160:163], v[56:59]
    buffer_load_dwordx4 v[160:163], v190, s[4:7], s23 offen sc1
    v_mfma_f32_16x16x32_bf16 v[60:63], v[168:171], v[164:167], v[60:63]
    buffer_load_dwordx4 v[168:171], v192, s[4:7], s24 offen sc1
    v_mfma_f32_16x16x32_bf16 v[64:67], v[172:175], v[164:167], v[64:67]
    buffer_load_dwordx4 v[172:175], v192, s[4:7], s24 offen offset:1024 sc1
    v_mfma_f32_16x16x32_bf16 v[68:71], v[176:179], v[164:167], v[68:71]
    buffer_load_dwordx4 v[176:179], v192, s[4:7], s24 offen offset:2048 sc1
    v_mfma_f32_16x16x32_bf16 v[72:75], v[180:183], v[164:167], v[72:75]
    buffer_load_dwordx4 v[180:183], v192, s[4:7], s24 offen offset:3072 sc1
    v_mfma_f32_16x16x32_bf16 v[76:79], v[184:187], v[164:167], v[76:79]
    buffer_load_dwordx4 v[164:167], v191, s[4:7], s23 offen sc1
    buffer_load_dwordx4 v[184:187], v241, s[4:7], s24 offen sc1
    s_add_u32 s23, s23, 4096
    s_add_u32 s24, s24, 40960
    s_waitcnt vmcnt(18) lgkmcnt(0)
    v_mfma_f32_16x16x32_bf16 v[0:3], v[96:99], v[80:83], v[0:3]
    v_mfma_f32_16x16x32_bf16 v[4:7], v[100:103], v[80:83], v[4:7]
    v_mfma_f32_16x16x32_bf16 v[8:11], v[104:107], v[80:83], v[8:11]
    v_mfma_f32_16x16x32_bf16 v[12:15], v[108:111], v[80:83], v[12:15]
    v_mfma_f32_16x16x32_bf16 v[16:19], v[112:115], v[80:83], v[16:19]
    v_mfma_f32_16x16x32_bf16 v[20:23], v[96:99], v[84:87], v[20:23]
    v_mfma_f32_16x16x32_bf16 v[24:27], v[100:103], v[84:87], v[24:27]
    v_mfma_f32_16x16x32_bf16 v[28:31], v[104:107], v[84:87], v[28:31]
    v_mfma_f32_16x16x32_bf16 v[32:35], v[108:111], v[84:87], v[32:35]
    v_mfma_f32_16x16x32_bf16 v[36:39], v[112:115], v[84:87], v[36:39]
    v_mfma_f32_16x16x32_bf16 v[40:43], v[96:99], v[88:91], v[40:43]
    v_mfma_f32_16x16x32_bf16 v[44:47], v[100:103], v[88:91], v[44:47]
    v_mfma_f32_16x16x32_bf16 v[48:51], v[104:107], v[88:91], v[48:51]
    v_mfma_f32_16x16x32_bf16 v[52:55], v[108:111], v[88:91], v[52:55]
    v_mfma_f32_16x16x32_bf16 v[56:59], v[112:115], v[88:91], v[56:59]
    v_mfma_f32_16x16x32_bf16 v[60:63], v[96:99], v[92:95], v[60:63]
    v_mfma_f32_16x16x32_bf16 v[64:67], v[100:103], v[92:95], v[64:67]
    v_mfma_f32_16x16x32_bf16 v[68:71], v[104:107], v[92:95], v[68:71]
    v_mfma_f32_16x16x32_bf16 v[72:75], v[108:111], v[92:95], v[72:75]
    v_mfma_f32_16x16x32_bf16 v[76:79], v[112:115], v[92:95], v[76:79]
    s_waitcnt vmcnt(9) lgkmcnt(0)
    v_mfma_f32_16x16x32_bf16 v[0:3], v[132:135], v[116:119], v[0:3]
    v_mfma_f32_16x16x32_bf16 v[4:7], v[136:139], v[116:119], v[4:7]
    v_mfma_f32_16x16x32_bf16 v[8:11], v[140:143], v[116:119], v[8:11]
    v_mfma_f32_16x16x32_bf16 v[12:15], v[144:147], v[116:119], v[12:15]
    v_mfma_f32_16x16x32_bf16 v[16:19], v[148:151], v[116:119], v[16:19]
    v_mfma_f32_16x16x32_bf16 v[20:23], v[132:135], v[120:123], v[20:23]
    v_mfma_f32_16x16x32_bf16 v[24:27], v[136:139], v[120:123], v[24:27]
    v_mfma_f32_16x16x32_bf16 v[28:31], v[140:143], v[120:123], v[28:31]
    v_mfma_f32_16x16x32_bf16 v[32:35], v[144:147], v[120:123], v[32:35]
    v_mfma_f32_16x16x32_bf16 v[36:39], v[148:151], v[120:123], v[36:39]
    v_mfma_f32_16x16x32_bf16 v[40:43], v[132:135], v[124:127], v[40:43]
    v_mfma_f32_16x16x32_bf16 v[44:47], v[136:139], v[124:127], v[44:47]
    v_mfma_f32_16x16x32_bf16 v[48:51], v[140:143], v[124:127], v[48:51]
    v_mfma_f32_16x16x32_bf16 v[52:55], v[144:147], v[124:127], v[52:55]
    v_mfma_f32_16x16x32_bf16 v[56:59], v[148:151], v[124:127], v[56:59]
    v_mfma_f32_16x16x32_bf16 v[60:63], v[132:135], v[128:131], v[60:63]
    v_mfma_f32_16x16x32_bf16 v[64:67], v[136:139], v[128:131], v[64:67]
    v_mfma_f32_16x16x32_bf16 v[68:71], v[140:143], v[128:131], v[68:71]
    v_mfma_f32_16x16x32_bf16 v[72:75], v[144:147], v[128:131], v[72:75]
    v_mfma_f32_16x16x32_bf16 v[76:79], v[148:151], v[128:131], v[76:79]
    s_waitcnt vmcnt(0) lgkmcnt(0)
    v_mfma_f32_16x16x32_bf16 v[0:3], v[168:171], v[152:155], v[0:3]
    v_mfma_f32_16x16x32_bf16 v[4:7], v[172:175], v[152:155], v[4:7]
    v_mfma_f32_16x16x32_bf16 v[8:11], v[176:179], v[152:155], v[8:11]
    v_mfma_f32_16x16x32_bf16 v[12:15], v[180:183], v[152:155], v[12:15]
    v_mfma_f32_16x16x32_bf16 v[16:19], v[184:187], v[152:155], v[16:19]
    v_mfma_f32_16x16x32_bf16 v[20:23], v[168:171], v[156:159], v[20:23]
    v_mfma_f32_16x16x32_bf16 v[24:27], v[172:175], v[156:159], v[24:27]
    v_mfma_f32_16x16x32_bf16 v[28:31], v[176:179], v[156:159], v[28:31]
    v_mfma_f32_16x16x32_bf16 v[32:35], v[180:183], v[156:159], v[32:35]
    v_mfma_f32_16x16x32_bf16 v[36:39], v[184:187], v[156:159], v[36:39]
    v_mfma_f32_16x16x32_bf16 v[40:43], v[168:171], v[160:163], v[40:43]
    v_mfma_f32_16x16x32_bf16 v[44:47], v[172:175], v[160:163], v[44:47]
    v_mfma_f32_16x16x32_bf16 v[48:51], v[176:179], v[160:163], v[48:51]
    v_mfma_f32_16x16x32_bf16 v[52:55], v[180:183], v[160:163], v[52:55]
    v_mfma_f32_16x16x32_bf16 v[56:59], v[184:187], v[160:163], v[56:59]
    v_mfma_f32_16x16x32_bf16 v[60:63], v[168:171], v[164:167], v[60:63]
    v_mfma_f32_16x16x32_bf16 v[64:67], v[172:175], v[164:167], v[64:67]
    v_mfma_f32_16x16x32_bf16 v[68:71], v[176:179], v[164:167], v[68:71]
    v_mfma_f32_16x16x32_bf16 v[72:75], v[180:183], v[164:167], v[72:75]
    v_mfma_f32_16x16x32_bf16 v[76:79], v[184:187], v[164:167], v[76:79]
    s_branch K2_FIN
K2_OSTREAM:
    s_lshl_b32 s26, s20, 2
    s_add_u32 s26, s26, 147520
    v_mov_b32 v230, s26
    s_mov_b32 s50, 2097152
K_SPINBAOSTREAM_33:
    ds_read_b32 v231, v230
    s_sub_u32 s50, s50, 1
    s_cmp_eq_u32 s50, 0
    s_cbranch_scc1 K_SPINDBAOSTREAM_34
    s_waitcnt lgkmcnt(0)
    v_cmp_gt_u32 vcc, 3, v231
    s_nop 3
    s_cbranch_vccnz K_SPINBAOSTREAM_33
K_SPINDBAOSTREAM_34:
    s_waitcnt lgkmcnt(0)
    ds_read_b128 v[96:99], v193 offset:0
    ds_read_b128 v[100:103], v193 offset:1024
    ds_read_b128 v[104:107], v193 offset:2048
    ds_read_b128 v[108:111], v193 offset:3072
    ds_read_b128 v[112:115], v193 offset:4096
    s_waitcnt vmcnt(8) lgkmcnt(0)
    v_mfma_f32_16x16x32_bf16 v[0:3], v[96:99], v[80:83], v[0:3]
    ds_read_b128 v[132:135], v193 offset:5120
    v_mfma_f32_16x16x32_bf16 v[4:7], v[100:103], v[80:83], v[4:7]
    ds_read_b128 v[136:139], v193 offset:6144
    v_mfma_f32_16x16x32_bf16 v[8:11], v[104:107], v[80:83], v[8:11]
    ds_read_b128 v[140:143], v193 offset:7168
    v_mfma_f32_16x16x32_bf16 v[12:15], v[108:111], v[80:83], v[12:15]
    ds_read_b128 v[144:147], v193 offset:8192
    v_mfma_f32_16x16x32_bf16 v[16:19], v[112:115], v[80:83], v[16:19]
    ds_read_b128 v[148:151], v193 offset:9216
    buffer_load_dwordx4 v[80:83], v188, s[4:7], s23 offen sc1
    v_mfma_f32_16x16x32_bf16 v[20:23], v[96:99], v[84:87], v[20:23]
    v_mfma_f32_16x16x32_bf16 v[24:27], v[100:103], v[84:87], v[24:27]
    v_mfma_f32_16x16x32_bf16 v[28:31], v[104:107], v[84:87], v[28:31]
    v_mfma_f32_16x16x32_bf16 v[32:35], v[108:111], v[84:87], v[32:35]
    v_mfma_f32_16x16x32_bf16 v[36:39], v[112:115], v[84:87], v[36:39]
    buffer_load_dwordx4 v[84:87], v189, s[4:7], s23 offen sc1
    v_mfma_f32_16x16x32_bf16 v[40:43], v[96:99], v[88:91], v[40:43]
    v_mfma_f32_16x16x32_bf16 v[44:47], v[100:103], v[88:91], v[44:47]
    v_mfma_f32_16x16x32_bf16 v[48:51], v[104:107], v[88:91], v[48:51]
    v_mfma_f32_16x16x32_bf16 v[52:55], v[108:111], v[88:91], v[52:55]
    v_mfma_f32_16x16x32_bf16 v[56:59], v[112:115], v[88:91], v[56:59]
    buffer_load_dwordx4 v[88:91], v190, s[4:7], s23 offen sc1
    v_mfma_f32_16x16x32_bf16 v[60:63], v[96:99], v[92:95], v[60:63]
    v_mfma_f32_16x16x32_bf16 v[64:67], v[100:103], v[92:95], v[64:67]
    v_mfma_f32_16x16x32_bf16 v[68:71], v[104:107], v[92:95], v[68:71]
    v_mfma_f32_16x16x32_bf16 v[72:75], v[108:111], v[92:95], v[72:75]
    v_mfma_f32_16x16x32_bf16 v[76:79], v[112:115], v[92:95], v[76:79]
    buffer_load_dwordx4 v[92:95], v191, s[4:7], s23 offen sc1
    s_add_u32 s23, s23, 4096
    s_waitcnt vmcnt(8) lgkmcnt(0)
    v_mfma_f32_16x16x32_bf16 v[0:3], v[132:135], v[116:119], v[0:3]
    ds_read_b128 v[168:171], v193 offset:10240
    v_mfma_f32_16x16x32_bf16 v[4:7], v[136:139], v[116:119], v[4:7]
    ds_read_b128 v[172:175], v193 offset:11264
    v_mfma_f32_16x16x32_bf16 v[8:11], v[140:143], v[116:119], v[8:11]
    ds_read_b128 v[176:179], v193 offset:12288
    v_mfma_f32_16x16x32_bf16 v[12:15], v[144:147], v[116:119], v[12:15]
    ds_read_b128 v[180:183], v193 offset:13312
    v_mfma_f32_16x16x32_bf16 v[16:19], v[148:151], v[116:119], v[16:19]
    ds_read_b128 v[184:187], v193 offset:14336
    buffer_load_dwordx4 v[116:119], v188, s[4:7], s23 offen sc1
    v_mfma_f32_16x16x32_bf16 v[20:23], v[132:135], v[120:123], v[20:23]
    v_mfma_f32_16x16x32_bf16 v[24:27], v[136:139], v[120:123], v[24:27]
    v_mfma_f32_16x16x32_bf16 v[28:31], v[140:143], v[120:123], v[28:31]
    v_mfma_f32_16x16x32_bf16 v[32:35], v[144:147], v[120:123], v[32:35]
    v_mfma_f32_16x16x32_bf16 v[36:39], v[148:151], v[120:123], v[36:39]
    buffer_load_dwordx4 v[120:123], v189, s[4:7], s23 offen sc1
    v_mfma_f32_16x16x32_bf16 v[40:43], v[132:135], v[124:127], v[40:43]
    v_mfma_f32_16x16x32_bf16 v[44:47], v[136:139], v[124:127], v[44:47]
    v_mfma_f32_16x16x32_bf16 v[48:51], v[140:143], v[124:127], v[48:51]
    v_mfma_f32_16x16x32_bf16 v[52:55], v[144:147], v[124:127], v[52:55]
    v_mfma_f32_16x16x32_bf16 v[56:59], v[148:151], v[124:127], v[56:59]
    buffer_load_dwordx4 v[124:127], v190, s[4:7], s23 offen sc1
    v_mfma_f32_16x16x32_bf16 v[60:63], v[132:135], v[128:131], v[60:63]
    v_mfma_f32_16x16x32_bf16 v[64:67], v[136:139], v[128:131], v[64:67]
    v_mfma_f32_16x16x32_bf16 v[68:71], v[140:143], v[128:131], v[68:71]
    v_mfma_f32_16x16x32_bf16 v[72:75], v[144:147], v[128:131], v[72:75]
    v_mfma_f32_16x16x32_bf16 v[76:79], v[148:151], v[128:131], v[76:79]
    buffer_load_dwordx4 v[128:131], v191, s[4:7], s23 offen sc1
    s_add_u32 s23, s23, 4096
    s_waitcnt vmcnt(8) lgkmcnt(0)
    s_lshl_b32 s26, s20, 2
    s_add_u32 s26, s26, 147520
    v_mov_b32 v230, s26
    s_mov_b32 s50, 2097152
K_SPINBBOSTREAM_35:
    ds_read_b32 v231, v230
    s_sub_u32 s50, s50, 1
    s_cmp_eq_u32 s50, 0
    s_cbranch_scc1 K_SPINDBBOSTREAM_36
    s_waitcnt lgkmcnt(0)
    v_cmp_gt_u32 vcc, 7, v231
    s_nop 3
    s_cbranch_vccnz K_SPINBBOSTREAM_35
K_SPINDBBOSTREAM_36:
    s_waitcnt lgkmcnt(0)
    v_mfma_f32_16x16x32_bf16 v[0:3], v[168:171], v[152:155], v[0:3]
    ds_read_b128 v[96:99], v193 offset:15360
    v_mfma_f32_16x16x32_bf16 v[4:7], v[172:175], v[152:155], v[4:7]
    ds_read_b128 v[100:103], v193 offset:16384
    v_mfma_f32_16x16x32_bf16 v[8:11], v[176:179], v[152:155], v[8:11]
    ds_read_b128 v[104:107], v193 offset:17408
    v_mfma_f32_16x16x32_bf16 v[12:15], v[180:183], v[152:155], v[12:15]
    ds_read_b128 v[108:111], v193 offset:18432
    v_mfma_f32_16x16x32_bf16 v[16:19], v[184:187], v[152:155], v[16:19]
    ds_read_b128 v[112:115], v193 offset:19456
    buffer_load_dwordx4 v[152:155], v188, s[4:7], s23 offen sc1
    v_mfma_f32_16x16x32_bf16 v[20:23], v[168:171], v[156:159], v[20:23]
    v_mfma_f32_16x16x32_bf16 v[24:27], v[172:175], v[156:159], v[24:27]
    v_mfma_f32_16x16x32_bf16 v[28:31], v[176:179], v[156:159], v[28:31]
    v_mfma_f32_16x16x32_bf16 v[32:35], v[180:183], v[156:159], v[32:35]
    v_mfma_f32_16x16x32_bf16 v[36:39], v[184:187], v[156:159], v[36:39]
    buffer_load_dwordx4 v[156:159], v189, s[4:7], s23 offen sc1
    v_mfma_f32_16x16x32_bf16 v[40:43], v[168:171], v[160:163], v[40:43]
    v_mfma_f32_16x16x32_bf16 v[44:47], v[172:175], v[160:163], v[44:47]
    v_mfma_f32_16x16x32_bf16 v[48:51], v[176:179], v[160:163], v[48:51]
    v_mfma_f32_16x16x32_bf16 v[52:55], v[180:183], v[160:163], v[52:55]
    v_mfma_f32_16x16x32_bf16 v[56:59], v[184:187], v[160:163], v[56:59]
    buffer_load_dwordx4 v[160:163], v190, s[4:7], s23 offen sc1
    v_mfma_f32_16x16x32_bf16 v[60:63], v[168:171], v[164:167], v[60:63]
    v_mfma_f32_16x16x32_bf16 v[64:67], v[172:175], v[164:167], v[64:67]
    v_mfma_f32_16x16x32_bf16 v[68:71], v[176:179], v[164:167], v[68:71]
    v_mfma_f32_16x16x32_bf16 v[72:75], v[180:183], v[164:167], v[72:75]
    v_mfma_f32_16x16x32_bf16 v[76:79], v[184:187], v[164:167], v[76:79]
    buffer_load_dwordx4 v[164:167], v191, s[4:7], s23 offen sc1
    s_add_u32 s23, s23, 4096
    s_waitcnt vmcnt(8) lgkmcnt(0)
    v_mfma_f32_16x16x32_bf16 v[0:3], v[96:99], v[80:83], v[0:3]
    ds_read_b128 v[132:135], v193 offset:20480
    v_mfma_f32_16x16x32_bf16 v[4:7], v[100:103], v[80:83], v[4:7]
    ds_read_b128 v[136:139], v193 offset:21504
    v_mfma_f32_16x16x32_bf16 v[8:11], v[104:107], v[80:83], v[8:11]
    ds_read_b128 v[140:143], v193 offset:22528
    v_mfma_f32_16x16x32_bf16 v[12:15], v[108:111], v[80:83], v[12:15]
    ds_read_b128 v[144:147], v193 offset:23552
    v_mfma_f32_16x16x32_bf16 v[16:19], v[112:115], v[80:83], v[16:19]
    ds_read_b128 v[148:151], v193 offset:24576
    buffer_load_dwordx4 v[80:83], v188, s[4:7], s23 offen sc1
    v_mfma_f32_16x16x32_bf16 v[20:23], v[96:99], v[84:87], v[20:23]
    v_mfma_f32_16x16x32_bf16 v[24:27], v[100:103], v[84:87], v[24:27]
    v_mfma_f32_16x16x32_bf16 v[28:31], v[104:107], v[84:87], v[28:31]
    v_mfma_f32_16x16x32_bf16 v[32:35], v[108:111], v[84:87], v[32:35]
    v_mfma_f32_16x16x32_bf16 v[36:39], v[112:115], v[84:87], v[36:39]
    buffer_load_dwordx4 v[84:87], v189, s[4:7], s23 offen sc1
    v_mfma_f32_16x16x32_bf16 v[40:43], v[96:99], v[88:91], v[40:43]
    v_mfma_f32_16x16x32_bf16 v[44:47], v[100:103], v[88:91], v[44:47]
    v_mfma_f32_16x16x32_bf16 v[48:51], v[104:107], v[88:91], v[48:51]
    v_mfma_f32_16x16x32_bf16 v[52:55], v[108:111], v[88:91], v[52:55]
    v_mfma_f32_16x16x32_bf16 v[56:59], v[112:115], v[88:91], v[56:59]
    buffer_load_dwordx4 v[88:91], v190, s[4:7], s23 offen sc1
    v_mfma_f32_16x16x32_bf16 v[60:63], v[96:99], v[92:95], v[60:63]
    v_mfma_f32_16x16x32_bf16 v[64:67], v[100:103], v[92:95], v[64:67]
    v_mfma_f32_16x16x32_bf16 v[68:71], v[104:107], v[92:95], v[68:71]
    v_mfma_f32_16x16x32_bf16 v[72:75], v[108:111], v[92:95], v[72:75]
    v_mfma_f32_16x16x32_bf16 v[76:79], v[112:115], v[92:95], v[76:79]
    buffer_load_dwordx4 v[92:95], v191, s[4:7], s23 offen sc1
    s_add_u32 s23, s23, 4096
    s_waitcnt vmcnt(8) lgkmcnt(0)
    v_mfma_f32_16x16x32_bf16 v[0:3], v[132:135], v[116:119], v[0:3]
    ds_read_b128 v[168:171], v193 offset:25600
    v_mfma_f32_16x16x32_bf16 v[4:7], v[136:139], v[116:119], v[4:7]
    ds_read_b128 v[172:175], v193 offset:26624
    v_mfma_f32_16x16x32_bf16 v[8:11], v[140:143], v[116:119], v[8:11]
    ds_read_b128 v[176:179], v193 offset:27648
    v_mfma_f32_16x16x32_bf16 v[12:15], v[144:147], v[116:119], v[12:15]
    ds_read_b128 v[180:183], v193 offset:28672
    v_mfma_f32_16x16x32_bf16 v[16:19], v[148:151], v[116:119], v[16:19]
    ds_read_b128 v[184:187], v193 offset:29696
    buffer_load_dwordx4 v[116:119], v188, s[4:7], s23 offen sc1
    v_mfma_f32_16x16x32_bf16 v[20:23], v[132:135], v[120:123], v[20:23]
    v_mfma_f32_16x16x32_bf16 v[24:27], v[136:139], v[120:123], v[24:27]
    v_mfma_f32_16x16x32_bf16 v[28:31], v[140:143], v[120:123], v[28:31]
    v_mfma_f32_16x16x32_bf16 v[32:35], v[144:147], v[120:123], v[32:35]
    v_mfma_f32_16x16x32_bf16 v[36:39], v[148:151], v[120:123], v[36:39]
    buffer_load_dwordx4 v[120:123], v189, s[4:7], s23 offen sc1
    v_mfma_f32_16x16x32_bf16 v[40:43], v[132:135], v[124:127], v[40:43]
    v_mfma_f32_16x16x32_bf16 v[44:47], v[136:139], v[124:127], v[44:47]
    v_mfma_f32_16x16x32_bf16 v[48:51], v[140:143], v[124:127], v[48:51]
    v_mfma_f32_16x16x32_bf16 v[52:55], v[144:147], v[124:127], v[52:55]
    v_mfma_f32_16x16x32_bf16 v[56:59], v[148:151], v[124:127], v[56:59]
    buffer_load_dwordx4 v[124:127], v190, s[4:7], s23 offen sc1
    v_mfma_f32_16x16x32_bf16 v[60:63], v[132:135], v[128:131], v[60:63]
    buffer_load_dwordx4 v[132:135], v192, s[4:7], s24 offen sc1
    v_mfma_f32_16x16x32_bf16 v[64:67], v[136:139], v[128:131], v[64:67]
    buffer_load_dwordx4 v[136:139], v192, s[4:7], s24 offen offset:1024 sc1
    v_mfma_f32_16x16x32_bf16 v[68:71], v[140:143], v[128:131], v[68:71]
    buffer_load_dwordx4 v[140:143], v192, s[4:7], s24 offen offset:2048 sc1
    v_mfma_f32_16x16x32_bf16 v[72:75], v[144:147], v[128:131], v[72:75]
    buffer_load_dwordx4 v[144:147], v192, s[4:7], s24 offen offset:3072 sc1
    v_mfma_f32_16x16x32_bf16 v[76:79], v[148:151], v[128:131], v[76:79]
    buffer_load_dwordx4 v[128:131], v191, s[4:7], s23 offen sc1
    buffer_load_dwordx4 v[148:151], v241, s[4:7], s24 offen sc1
    s_add_u32 s23, s23, 4096
    s_add_u32 s24, s24, 40960
    s_waitcnt vmcnt(13) lgkmcnt(0)
    v_mfma_f32_16x16x32_bf16 v[0:3], v[168:171], v[152:155], v[0:3]
    ds_read_b128 v[96:99], v193 offset:30720
    v_mfma_f32_16x16x32_bf16 v[4:7], v[172:175], v[152:155], v[4:7]
    ds_read_b128 v[100:103], v193 offset:31744
    v_mfma_f32_16x16x32_bf16 v[8:11], v[176:179], v[152:155], v[8:11]
    ds_read_b128 v[104:107], v193 offset:32768
    v_mfma_f32_16x16x32_bf16 v[12:15], v[180:183], v[152:155], v[12:15]
    ds_read_b128 v[108:111], v193 offset:33792
    v_mfma_f32_16x16x32_bf16 v[16:19], v[184:187], v[152:155], v[16:19]
    ds_read_b128 v[112:115], v193 offset:34816
    buffer_load_dwordx4 v[152:155], v188, s[4:7], s23 offen sc1
    v_mfma_f32_16x16x32_bf16 v[20:23], v[168:171], v[156:159], v[20:23]
    v_mfma_f32_16x16x32_bf16 v[24:27], v[172:175], v[156:159], v[24:27]
    v_mfma_f32_16x16x32_bf16 v[28:31], v[176:179], v[156:159], v[28:31]
    v_mfma_f32_16x16x32_bf16 v[32:35], v[180:183], v[156:159], v[32:35]
    v_mfma_f32_16x16x32_bf16 v[36:39], v[184:187], v[156:159], v[36:39]
    buffer_load_dwordx4 v[156:159], v189, s[4:7], s23 offen sc1
    v_mfma_f32_16x16x32_bf16 v[40:43], v[168:171], v[160:163], v[40:43]
    v_mfma_f32_16x16x32_bf16 v[44:47], v[172:175], v[160:163], v[44:47]
    v_mfma_f32_16x16x32_bf16 v[48:51], v[176:179], v[160:163], v[48:51]
    v_mfma_f32_16x16x32_bf16 v[52:55], v[180:183], v[160:163], v[52:55]
    v_mfma_f32_16x16x32_bf16 v[56:59], v[184:187], v[160:163], v[56:59]
    buffer_load_dwordx4 v[160:163], v190, s[4:7], s23 offen sc1
    v_mfma_f32_16x16x32_bf16 v[60:63], v[168:171], v[164:167], v[60:63]
    buffer_load_dwordx4 v[168:171], v192, s[4:7], s24 offen sc1
    v_mfma_f32_16x16x32_bf16 v[64:67], v[172:175], v[164:167], v[64:67]
    buffer_load_dwordx4 v[172:175], v192, s[4:7], s24 offen offset:1024 sc1
    v_mfma_f32_16x16x32_bf16 v[68:71], v[176:179], v[164:167], v[68:71]
    buffer_load_dwordx4 v[176:179], v192, s[4:7], s24 offen offset:2048 sc1
    v_mfma_f32_16x16x32_bf16 v[72:75], v[180:183], v[164:167], v[72:75]
    buffer_load_dwordx4 v[180:183], v192, s[4:7], s24 offen offset:3072 sc1
    v_mfma_f32_16x16x32_bf16 v[76:79], v[184:187], v[164:167], v[76:79]
    buffer_load_dwordx4 v[164:167], v191, s[4:7], s23 offen sc1
    buffer_load_dwordx4 v[184:187], v241, s[4:7], s24 offen sc1
    s_add_u32 s23, s23, 4096
    s_add_u32 s24, s24, 40960
    s_waitcnt vmcnt(18) lgkmcnt(0)
    v_mfma_f32_16x16x32_bf16 v[0:3], v[96:99], v[80:83], v[0:3]
    v_mfma_f32_16x16x32_bf16 v[4:7], v[100:103], v[80:83], v[4:7]
    v_mfma_f32_16x16x32_bf16 v[8:11], v[104:107], v[80:83], v[8:11]
    v_mfma_f32_16x16x32_bf16 v[12:15], v[108:111], v[80:83], v[12:15]
    v_mfma_f32_16x16x32_bf16 v[16:19], v[112:115], v[80:83], v[16:19]
    buffer_load_dwordx4 v[80:83], v188, s[4:7], s23 offen sc1
    v_mfma_f32_16x16x32_bf16 v[20:23], v[96:99], v[84:87], v[20:23]
    v_mfma_f32_16x16x32_bf16 v[24:27], v[100:103], v[84:87], v[24:27]
    v_mfma_f32_16x16x32_bf16 v[28:31], v[104:107], v[84:87], v[28:31]
    v_mfma_f32_16x16x32_bf16 v[32:35], v[108:111], v[84:87], v[32:35]
    v_mfma_f32_16x16x32_bf16 v[36:39], v[112:115], v[84:87], v[36:39]
    buffer_load_dwordx4 v[84:87], v189, s[4:7], s23 offen sc1
    v_mfma_f32_16x16x32_bf16 v[40:43], v[96:99], v[88:91], v[40:43]
    v_mfma_f32_16x16x32_bf16 v[44:47], v[100:103], v[88:91], v[44:47]
    v_mfma_f32_16x16x32_bf16 v[48:51], v[104:107], v[88:91], v[48:51]
    v_mfma_f32_16x16x32_bf16 v[52:55], v[108:111], v[88:91], v[52:55]
    v_mfma_f32_16x16x32_bf16 v[56:59], v[112:115], v[88:91], v[56:59]
    buffer_load_dwordx4 v[88:91], v190, s[4:7], s23 offen sc1
    v_mfma_f32_16x16x32_bf16 v[60:63], v[96:99], v[92:95], v[60:63]
    buffer_load_dwordx4 v[96:99], v192, s[4:7], s24 offen sc1
    v_mfma_f32_16x16x32_bf16 v[64:67], v[100:103], v[92:95], v[64:67]
    buffer_load_dwordx4 v[100:103], v192, s[4:7], s24 offen offset:1024 sc1
    v_mfma_f32_16x16x32_bf16 v[68:71], v[104:107], v[92:95], v[68:71]
    buffer_load_dwordx4 v[104:107], v192, s[4:7], s24 offen offset:2048 sc1
    v_mfma_f32_16x16x32_bf16 v[72:75], v[108:111], v[92:95], v[72:75]
    buffer_load_dwordx4 v[108:111], v192, s[4:7], s24 offen offset:3072 sc1
    v_mfma_f32_16x16x32_bf16 v[76:79], v[112:115], v[92:95], v[76:79]
    buffer_load_dwordx4 v[92:95], v191, s[4:7], s23 offen sc1
    buffer_load_dwordx4 v[112:115], v241, s[4:7], s24 offen sc1
    s_add_u32 s23, s23, 4096
    s_add_u32 s24, s24, 40960
    s_waitcnt vmcnt(18) lgkmcnt(0)
    v_mfma_f32_16x16x32_bf16 v[0:3], v[132:135], v[116:119], v[0:3]
    v_mfma_f32_16x16x32_bf16 v[4:7], v[136:139], v[116:119], v[4:7]
    v_mfma_f32_16x16x32_bf16 v[8:11], v[140:143], v[116:119], v[8:11]
    v_mfma_f32_16x16x32_bf16 v[12:15], v[144:147], v[116:119], v[12:15]
    v_mfma_f32_16x16x32_bf16 v[16:19], v[148:151], v[116:119], v[16:19]
    buffer_load_dwordx4 v[116:119], v188, s[4:7], s23 offen sc1
    v_mfma_f32_16x16x32_bf16 v[20:23], v[132:135], v[120:123], v[20:23]
    v_mfma_f32_16x16x32_bf16 v[24:27], v[136:139], v[120:123], v[24:27]
    v_mfma_f32_16x16x32_bf16 v[28:31], v[140:143], v[120:123], v[28:31]
    v_mfma_f32_16x16x32_bf16 v[32:35], v[144:147], v[120:123], v[32:35]
    v_mfma_f32_16x16x32_bf16 v[36:39], v[148:151], v[120:123], v[36:39]
    buffer_load_dwordx4 v[120:123], v189, s[4:7], s23 offen sc1
    v_mfma_f32_16x16x32_bf16 v[40:43], v[132:135], v[124:127], v[40:43]
    v_mfma_f32_16x16x32_bf16 v[44:47], v[136:139], v[124:127], v[44:47]
    v_mfma_f32_16x16x32_bf16 v[48:51], v[140:143], v[124:127], v[48:51]
    v_mfma_f32_16x16x32_bf16 v[52:55], v[144:147], v[124:127], v[52:55]
    v_mfma_f32_16x16x32_bf16 v[56:59], v[148:151], v[124:127], v[56:59]
    buffer_load_dwordx4 v[124:127], v190, s[4:7], s23 offen sc1
    v_mfma_f32_16x16x32_bf16 v[60:63], v[132:135], v[128:131], v[60:63]
    buffer_load_dwordx4 v[132:135], v192, s[4:7], s24 offen sc1
    v_mfma_f32_16x16x32_bf16 v[64:67], v[136:139], v[128:131], v[64:67]
    buffer_load_dwordx4 v[136:139], v192, s[4:7], s24 offen offset:1024 sc1
    v_mfma_f32_16x16x32_bf16 v[68:71], v[140:143], v[128:131], v[68:71]
    buffer_load_dwordx4 v[140:143], v192, s[4:7], s24 offen offset:2048 sc1
    v_mfma_f32_16x16x32_bf16 v[72:75], v[144:147], v[128:131], v[72:75]
    buffer_load_dwordx4 v[144:147], v192, s[4:7], s24 offen offset:3072 sc1
    v_mfma_f32_16x16x32_bf16 v[76:79], v[148:151], v[128:131], v[76:79]
    buffer_load_dwordx4 v[128:131], v191, s[4:7], s23 offen sc1
    buffer_load_dwordx4 v[148:151], v241, s[4:7], s24 offen sc1
    s_add_u32 s23, s23, 4096
    s_add_u32 s24, s24, 40960
    s_waitcnt vmcnt(18) lgkmcnt(0)
    v_mfma_f32_16x16x32_bf16 v[0:3], v[168:171], v[152:155], v[0:3]
    v_mfma_f32_16x16x32_bf16 v[4:7], v[172:175], v[152:155], v[4:7]
    v_mfma_f32_16x16x32_bf16 v[8:11], v[176:179], v[152:155], v[8:11]
    v_mfma_f32_16x16x32_bf16 v[12:15], v[180:183], v[152:155], v[12:15]
    v_mfma_f32_16x16x32_bf16 v[16:19], v[184:187], v[152:155], v[16:19]
    buffer_load_dwordx4 v[152:155], v188, s[4:7], s23 offen sc1
    v_mfma_f32_16x16x32_bf16 v[20:23], v[168:171], v[156:159], v[20:23]
    v_mfma_f32_16x16x32_bf16 v[24:27], v[172:175], v[156:159], v[24:27]
    v_mfma_f32_16x16x32_bf16 v[28:31], v[176:179], v[156:159], v[28:31]
    v_mfma_f32_16x16x32_bf16 v[32:35], v[180:183], v[156:159], v[32:35]
    v_mfma_f32_16x16x32_bf16 v[36:39], v[184:187], v[156:159], v[36:39]
    buffer_load_dwordx4 v[156:159], v189, s[4:7], s23 offen sc1
    v_mfma_f32_16x16x32_bf16 v[40:43], v[168:171], v[160:163], v[40:43]
    v_mfma_f32_16x16x32_bf16 v[44:47], v[172:175], v[160:163], v[44:47]
    v_mfma_f32_16x16x32_bf16 v[48:51], v[176:179], v[160:163], v[48:51]
    v_mfma_f32_16x16x32_bf16 v[52:55], v[180:183], v[160:163], v[52:55]
    v_mfma_f32_16x16x32_bf16 v[56:59], v[184:187], v[160:163], v[56:59]
    buffer_load_dwordx4 v[160:163], v190, s[4:7], s23 offen sc1
    v_mfma_f32_16x16x32_bf16 v[60:63], v[168:171], v[164:167], v[60:63]
    buffer_load_dwordx4 v[168:171], v192, s[4:7], s24 offen sc1
    v_mfma_f32_16x16x32_bf16 v[64:67], v[172:175], v[164:167], v[64:67]
    buffer_load_dwordx4 v[172:175], v192, s[4:7], s24 offen offset:1024 sc1
    v_mfma_f32_16x16x32_bf16 v[68:71], v[176:179], v[164:167], v[68:71]
    buffer_load_dwordx4 v[176:179], v192, s[4:7], s24 offen offset:2048 sc1
    v_mfma_f32_16x16x32_bf16 v[72:75], v[180:183], v[164:167], v[72:75]
    buffer_load_dwordx4 v[180:183], v192, s[4:7], s24 offen offset:3072 sc1
    v_mfma_f32_16x16x32_bf16 v[76:79], v[184:187], v[164:167], v[76:79]
    buffer_load_dwordx4 v[164:167], v191, s[4:7], s23 offen sc1
    buffer_load_dwordx4 v[184:187], v241, s[4:7], s24 offen sc1
    s_add_u32 s23, s23, 4096
    s_add_u32 s24, s24, 40960
    s_waitcnt vmcnt(18) lgkmcnt(0)
    v_mfma_f32_16x16x32_bf16 v[0:3], v[96:99], v[80:83], v[0:3]
    v_mfma_f32_16x16x32_bf16 v[4:7], v[100:103], v[80:83], v[4:7]
    v_mfma_f32_16x16x32_bf16 v[8:11], v[104:107], v[80:83], v[8:11]
    v_mfma_f32_16x16x32_bf16 v[12:15], v[108:111], v[80:83], v[12:15]
    v_mfma_f32_16x16x32_bf16 v[16:19], v[112:115], v[80:83], v[16:19]
    buffer_load_dwordx4 v[80:83], v188, s[4:7], s23 offen sc1
    v_mfma_f32_16x16x32_bf16 v[20:23], v[96:99], v[84:87], v[20:23]
    v_mfma_f32_16x16x32_bf16 v[24:27], v[100:103], v[84:87], v[24:27]
    v_mfma_f32_16x16x32_bf16 v[28:31], v[104:107], v[84:87], v[28:31]
    v_mfma_f32_16x16x32_bf16 v[32:35], v[108:111], v[84:87], v[32:35]
    v_mfma_f32_16x16x32_bf16 v[36:39], v[112:115], v[84:87], v[36:39]
    buffer_load_dwordx4 v[84:87], v189, s[4:7], s23 offen sc1
    v_mfma_f32_16x16x32_bf16 v[40:43], v[96:99], v[88:91], v[40:43]
    v_mfma_f32_16x16x32_bf16 v[44:47], v[100:103], v[88:91], v[44:47]
    v_mfma_f32_16x16x32_bf16 v[48:51], v[104:107], v[88:91], v[48:51]
    v_mfma_f32_16x16x32_bf16 v[52:55], v[108:111], v[88:91], v[52:55]
    v_mfma_f32_16x16x32_bf16 v[56:59], v[112:115], v[88:91], v[56:59]
    buffer_load_dwordx4 v[88:91], v190, s[4:7], s23 offen sc1
    v_mfma_f32_16x16x32_bf16 v[60:63], v[96:99], v[92:95], v[60:63]
    buffer_load_dwordx4 v[96:99], v192, s[4:7], s24 offen sc1
    v_mfma_f32_16x16x32_bf16 v[64:67], v[100:103], v[92:95], v[64:67]
    buffer_load_dwordx4 v[100:103], v192, s[4:7], s24 offen offset:1024 sc1
    v_mfma_f32_16x16x32_bf16 v[68:71], v[104:107], v[92:95], v[68:71]
    buffer_load_dwordx4 v[104:107], v192, s[4:7], s24 offen offset:2048 sc1
    v_mfma_f32_16x16x32_bf16 v[72:75], v[108:111], v[92:95], v[72:75]
    buffer_load_dwordx4 v[108:111], v192, s[4:7], s24 offen offset:3072 sc1
    v_mfma_f32_16x16x32_bf16 v[76:79], v[112:115], v[92:95], v[76:79]
    buffer_load_dwordx4 v[92:95], v191, s[4:7], s23 offen sc1
    buffer_load_dwordx4 v[112:115], v241, s[4:7], s24 offen sc1
    s_add_u32 s23, s23, 4096
    s_add_u32 s24, s24, 40960
    s_waitcnt vmcnt(18) lgkmcnt(0)
    v_mfma_f32_16x16x32_bf16 v[0:3], v[132:135], v[116:119], v[0:3]
    v_mfma_f32_16x16x32_bf16 v[4:7], v[136:139], v[116:119], v[4:7]
    v_mfma_f32_16x16x32_bf16 v[8:11], v[140:143], v[116:119], v[8:11]
    v_mfma_f32_16x16x32_bf16 v[12:15], v[144:147], v[116:119], v[12:15]
    v_mfma_f32_16x16x32_bf16 v[16:19], v[148:151], v[116:119], v[16:19]
    buffer_load_dwordx4 v[116:119], v188, s[4:7], s23 offen sc1
    v_mfma_f32_16x16x32_bf16 v[20:23], v[132:135], v[120:123], v[20:23]
    v_mfma_f32_16x16x32_bf16 v[24:27], v[136:139], v[120:123], v[24:27]
    v_mfma_f32_16x16x32_bf16 v[28:31], v[140:143], v[120:123], v[28:31]
    v_mfma_f32_16x16x32_bf16 v[32:35], v[144:147], v[120:123], v[32:35]
    v_mfma_f32_16x16x32_bf16 v[36:39], v[148:151], v[120:123], v[36:39]
    buffer_load_dwordx4 v[120:123], v189, s[4:7], s23 offen sc1
    v_mfma_f32_16x16x32_bf16 v[40:43], v[132:135], v[124:127], v[40:43]
    v_mfma_f32_16x16x32_bf16 v[44:47], v[136:139], v[124:127], v[44:47]
    v_mfma_f32_16x16x32_bf16 v[48:51], v[140:143], v[124:127], v[48:51]
    v_mfma_f32_16x16x32_bf16 v[52:55], v[144:147], v[124:127], v[52:55]
    v_mfma_f32_16x16x32_bf16 v[56:59], v[148:151], v[124:127], v[56:59]
    buffer_load_dwordx4 v[124:127], v190, s[4:7], s23 offen sc1
    v_mfma_f32_16x16x32_bf16 v[60:63], v[132:135], v[128:131], v[60:63]
    buffer_load_dwordx4 v[132:135], v192, s[4:7], s24 offen sc1
    v_mfma_f32_16x16x32_bf16 v[64:67], v[136:139], v[128:131], v[64:67]
    buffer_load_dwordx4 v[136:139], v192, s[4:7], s24 offen offset:1024 sc1
    v_mfma_f32_16x16x32_bf16 v[68:71], v[140:143], v[128:131], v[68:71]
    buffer_load_dwordx4 v[140:143], v192, s[4:7], s24 offen offset:2048 sc1
    v_mfma_f32_16x16x32_bf16 v[72:75], v[144:147], v[128:131], v[72:75]
    buffer_load_dwordx4 v[144:147], v192, s[4:7], s24 offen offset:3072 sc1
    v_mfma_f32_16x16x32_bf16 v[76:79], v[148:151], v[128:131], v[76:79]
    buffer_load_dwordx4 v[128:131], v191, s[4:7], s23 offen sc1
    buffer_load_dwordx4 v[148:151], v241, s[4:7], s24 offen sc1
    s_add_u32 s23, s23, 4096
    s_add_u32 s24, s24, 40960
    s_waitcnt vmcnt(18) lgkmcnt(0)
    v_mov_b32 v230, 147484
    s_mov_b32 s50, 2097152
K_SPINGOSTREAM_37:
    ds_read_b32 v231, v230
    s_sub_u32 s50, s50, 1
    s_cmp_eq_u32 s50, 0
    s_cbranch_scc1 K_SPINDGOSTREAM_38
    s_waitcnt lgkmcnt(0)
    v_cmp_ne_u32 vcc, 1, v231
    s_nop 3
    s_cbranch_vccnz K_SPINGOSTREAM_37
K_SPINDGOSTREAM_38:
    s_waitcnt lgkmcnt(0)
    buffer_load_dwordx2 v[194:195], v227, s[4:7], 0 offen sc1
    v_mfma_f32_16x16x32_bf16 v[0:3], v[168:171], v[152:155], v[0:3]
    v_mfma_f32_16x16x32_bf16 v[4:7], v[172:175], v[152:155], v[4:7]
    v_mfma_f32_16x16x32_bf16 v[8:11], v[176:179], v[152:155], v[8:11]
    v_mfma_f32_16x16x32_bf16 v[12:15], v[180:183], v[152:155], v[12:15]
    v_mfma_f32_16x16x32_bf16 v[16:19], v[184:187], v[152:155], v[16:19]
    buffer_load_dwordx4 v[152:155], v188, s[4:7], s23 offen sc1
    v_mfma_f32_16x16x32_bf16 v[20:23], v[168:171], v[156:159], v[20:23]
    v_mfma_f32_16x16x32_bf16 v[24:27], v[172:175], v[156:159], v[24:27]
    v_mfma_f32_16x16x32_bf16 v[28:31], v[176:179], v[156:159], v[28:31]
    v_mfma_f32_16x16x32_bf16 v[32:35], v[180:183], v[156:159], v[32:35]
    v_mfma_f32_16x16x32_bf16 v[36:39], v[184:187], v[156:159], v[36:39]
    buffer_load_dwordx4 v[156:159], v189, s[4:7], s23 offen sc1
    v_mfma_f32_16x16x32_bf16 v[40:43], v[168:171], v[160:163], v[40:43]
    v_mfma_f32_16x16x32_bf16 v[44:47], v[172:175], v[160:163], v[44:47]
    v_mfma_f32_16x16x32_bf16 v[48:51], v[176:179], v[160:163], v[48:51]
    v_mfma_f32_16x16x32_bf16 v[52:55], v[180:183], v[160:163], v[52:55]
    v_mfma_f32_16x16x32_bf16 v[56:59], v[184:187], v[160:163], v[56:59]
    buffer_load_dwordx4 v[160:163], v190, s[4:7], s23 offen sc1
    v_mfma_f32_16x16x32_bf16 v[60:63], v[168:171], v[164:167], v[60:63]
    buffer_load_dwordx4 v[168:171], v192, s[4:7], s24 offen sc1
    v_mfma_f32_16x16x32_bf16 v[64:67], v[172:175], v[164:167], v[64:67]
    buffer_load_dwordx4 v[172:175], v192, s[4:7], s24 offen offset:1024 sc1
    v_mfma_f32_16x16x32_bf16 v[68:71], v[176:179], v[164:167], v[68:71]
    buffer_load_dwordx4 v[176:179], v192, s[4:7], s24 offen offset:2048 sc1
    v_mfma_f32_16x16x32_bf16 v[72:75], v[180:183], v[164:167], v[72:75]
    buffer_load_dwordx4 v[180:183], v192, s[4:7], s24 offen offset:3072 sc1
    v_mfma_f32_16x16x32_bf16 v[76:79], v[184:187], v[164:167], v[76:79]
    buffer_load_dwordx4 v[164:167], v191, s[4:7], s23 offen sc1
    buffer_load_dwordx4 v[184:187], v241, s[4:7], s24 offen sc1
    s_add_u32 s23, s23, 4096
    s_add_u32 s24, s24, 40960
    s_waitcnt vmcnt(19) lgkmcnt(0)
    v_mfma_f32_16x16x32_bf16 v[0:3], v[96:99], v[80:83], v[0:3]
    v_mfma_f32_16x16x32_bf16 v[4:7], v[100:103], v[80:83], v[4:7]
    v_mfma_f32_16x16x32_bf16 v[8:11], v[104:107], v[80:83], v[8:11]
    v_mfma_f32_16x16x32_bf16 v[12:15], v[108:111], v[80:83], v[12:15]
    v_mfma_f32_16x16x32_bf16 v[16:19], v[112:115], v[80:83], v[16:19]
    buffer_load_dwordx4 v[80:83], v188, s[4:7], s23 offen sc1
    v_mfma_f32_16x16x32_bf16 v[20:23], v[96:99], v[84:87], v[20:23]
    v_mfma_f32_16x16x32_bf16 v[24:27], v[100:103], v[84:87], v[24:27]
    v_mfma_f32_16x16x32_bf16 v[28:31], v[104:107], v[84:87], v[28:31]
    v_mfma_f32_16x16x32_bf16 v[32:35], v[108:111], v[84:87], v[32:35]
    v_mfma_f32_16x16x32_bf16 v[36:39], v[112:115], v[84:87], v[36:39]
    buffer_load_dwordx4 v[84:87], v189, s[4:7], s23 offen sc1
    v_mfma_f32_16x16x32_bf16 v[40:43], v[96:99], v[88:91], v[40:43]
    v_mfma_f32_16x16x32_bf16 v[44:47], v[100:103], v[88:91], v[44:47]
    v_mfma_f32_16x16x32_bf16 v[48:51], v[104:107], v[88:91], v[48:51]
    v_mfma_f32_16x16x32_bf16 v[52:55], v[108:111], v[88:91], v[52:55]
    v_mfma_f32_16x16x32_bf16 v[56:59], v[112:115], v[88:91], v[56:59]
    buffer_load_dwordx4 v[88:91], v190, s[4:7], s23 offen sc1
    v_mfma_f32_16x16x32_bf16 v[60:63], v[96:99], v[92:95], v[60:63]
    buffer_load_dwordx4 v[96:99], v192, s[4:7], s24 offen sc1
    v_mfma_f32_16x16x32_bf16 v[64:67], v[100:103], v[92:95], v[64:67]
    buffer_load_dwordx4 v[100:103], v192, s[4:7], s24 offen offset:1024 sc1
    v_mfma_f32_16x16x32_bf16 v[68:71], v[104:107], v[92:95], v[68:71]
    buffer_load_dwordx4 v[104:107], v192, s[4:7], s24 offen offset:2048 sc1
    v_mfma_f32_16x16x32_bf16 v[72:75], v[108:111], v[92:95], v[72:75]
    buffer_load_dwordx4 v[108:111], v192, s[4:7], s24 offen offset:3072 sc1
    v_mfma_f32_16x16x32_bf16 v[76:79], v[112:115], v[92:95], v[76:79]
    buffer_load_dwordx4 v[92:95], v191, s[4:7], s23 offen sc1
    buffer_load_dwordx4 v[112:115], v241, s[4:7], s24 offen sc1
    s_add_u32 s23, s23, 4096
    s_add_u32 s24, s24, 40960
    s_waitcnt vmcnt(19) lgkmcnt(0)
    v_mfma_f32_16x16x32_bf16 v[0:3], v[132:135], v[116:119], v[0:3]
    v_mfma_f32_16x16x32_bf16 v[4:7], v[136:139], v[116:119], v[4:7]
    v_mfma_f32_16x16x32_bf16 v[8:11], v[140:143], v[116:119], v[8:11]
    v_mfma_f32_16x16x32_bf16 v[12:15], v[144:147], v[116:119], v[12:15]
    v_mfma_f32_16x16x32_bf16 v[16:19], v[148:151], v[116:119], v[16:19]
    v_lshlrev_b32 v226, 3, v240
    v_sub_u32 v188, v188, v226
    buffer_load_dwordx2 v[116:117], v188, s[4:7], s23 offen sc1
    buffer_load_dwordx2 v[118:119], v188, s[4:7], s23 offen offset:512 sc1
    v_mfma_f32_16x16x32_bf16 v[20:23], v[132:135], v[120:123], v[20:23]
    v_mfma_f32_16x16x32_bf16 v[24:27], v[136:139], v[120:123], v[24:27]
    v_mfma_f32_16x16x32_bf16 v[28:31], v[140:143], v[120:123], v[28:31]
    v_mfma_f32_16x16x32_bf16 v[32:35], v[144:147], v[120:123], v[32:35]
    v_mfma_f32_16x16x32_bf16 v[36:39], v[148:151], v[120:123], v[36:39]
    v_lshlrev_b32 v226, 3, v240
    v_sub_u32 v189, v189, v226
    buffer_load_dwordx2 v[120:121], v189, s[4:7], s23 offen sc1
    buffer_load_dwordx2 v[122:123], v189, s[4:7], s23 offen offset:512 sc1
    v_mfma_f32_16x16x32_bf16 v[40:43], v[132:135], v[124:127], v[40:43]
    v_mfma_f32_16x16x32_bf16 v[44:47], v[136:139], v[124:127], v[44:47]
    v_mfma_f32_16x16x32_bf16 v[48:51], v[140:143], v[124:127], v[48:51]
    v_mfma_f32_16x16x32_bf16 v[52:55], v[144:147], v[124:127], v[52:55]
    v_mfma_f32_16x16x32_bf16 v[56:59], v[148:151], v[124:127], v[56:59]
    v_lshlrev_b32 v226, 3, v240
    v_sub_u32 v190, v190, v226
    buffer_load_dwordx2 v[124:125], v190, s[4:7], s23 offen sc1
    buffer_load_dwordx2 v[126:127], v190, s[4:7], s23 offen offset:512 sc1
    v_mfma_f32_16x16x32_bf16 v[60:63], v[132:135], v[128:131], v[60:63]
    buffer_load_dwordx4 v[132:135], v192, s[4:7], s24 offen sc1
    v_mfma_f32_16x16x32_bf16 v[64:67], v[136:139], v[128:131], v[64:67]
    buffer_load_dwordx4 v[136:139], v192, s[4:7], s24 offen offset:1024 sc1
    v_mfma_f32_16x16x32_bf16 v[68:71], v[140:143], v[128:131], v[68:71]
    buffer_load_dwordx4 v[140:143], v192, s[4:7], s24 offen offset:2048 sc1
    v_mfma_f32_16x16x32_bf16 v[72:75], v[144:147], v[128:131], v[72:75]
    buffer_load_dwordx4 v[144:147], v192, s[4:7], s24 offen offset:3072 sc1
    v_mfma_f32_16x16x32_bf16 v[76:79], v[148:151], v[128:131], v[76:79]
    v_lshlrev_b32 v226, 3, v240
    v_sub_u32 v191, v191, v226
    buffer_load_dwordx2 v[128:129], v191, s[4:7], s23 offen sc1
    buffer_load_dwordx2 v[130:131], v191, s[4:7], s23 offen offset:512 sc1
    buffer_load_dwordx4 v[148:151], v241, s[4:7], s24 offen sc1
    s_add_u32 s23, s23, 4096
    s_add_u32 s24, s24, 40960
    s_waitcnt vmcnt(22) lgkmcnt(0)
    v_mfma_f32_16x16x32_bf16 v[0:3], v[168:171], v[152:155], v[0:3]
    v_mfma_f32_16x16x32_bf16 v[4:7], v[172:175], v[152:155], v[4:7]
    v_mfma_f32_16x16x32_bf16 v[8:11], v[176:179], v[152:155], v[8:11]
    v_mfma_f32_16x16x32_bf16 v[12:15], v[180:183], v[152:155], v[12:15]
    v_mfma_f32_16x16x32_bf16 v[16:19], v[184:187], v[152:155], v[16:19]
    buffer_load_dwordx2 v[152:153], v188, s[4:7], s23 offen sc1
    buffer_load_dwordx2 v[154:155], v188, s[4:7], s23 offen offset:512 sc1
    v_mfma_f32_16x16x32_bf16 v[20:23], v[168:171], v[156:159], v[20:23]
    v_mfma_f32_16x16x32_bf16 v[24:27], v[172:175], v[156:159], v[24:27]
    v_mfma_f32_16x16x32_bf16 v[28:31], v[176:179], v[156:159], v[28:31]
    v_mfma_f32_16x16x32_bf16 v[32:35], v[180:183], v[156:159], v[32:35]
    v_mfma_f32_16x16x32_bf16 v[36:39], v[184:187], v[156:159], v[36:39]
    buffer_load_dwordx2 v[156:157], v189, s[4:7], s23 offen sc1
    buffer_load_dwordx2 v[158:159], v189, s[4:7], s23 offen offset:512 sc1
    v_mfma_f32_16x16x32_bf16 v[40:43], v[168:171], v[160:163], v[40:43]
    v_mfma_f32_16x16x32_bf16 v[44:47], v[172:175], v[160:163], v[44:47]
    v_mfma_f32_16x16x32_bf16 v[48:51], v[176:179], v[160:163], v[48:51]
    v_mfma_f32_16x16x32_bf16 v[52:55], v[180:183], v[160:163], v[52:55]
    v_mfma_f32_16x16x32_bf16 v[56:59], v[184:187], v[160:163], v[56:59]
    buffer_load_dwordx2 v[160:161], v190, s[4:7], s23 offen sc1
    buffer_load_dwordx2 v[162:163], v190, s[4:7], s23 offen offset:512 sc1
    v_mfma_f32_16x16x32_bf16 v[60:63], v[168:171], v[164:167], v[60:63]
    buffer_load_dwordx4 v[168:171], v192, s[4:7], s24 offen sc1
    v_mfma_f32_16x16x32_bf16 v[64:67], v[172:175], v[164:167], v[64:67]
    buffer_load_dwordx4 v[172:175], v192, s[4:7], s24 offen offset:1024 sc1
    v_mfma_f32_16x16x32_bf16 v[68:71], v[176:179], v[164:167], v[68:71]
    buffer_load_dwordx4 v[176:179], v192, s[4:7], s24 offen offset:2048 sc1
    v_mfma_f32_16x16x32_bf16 v[72:75], v[180:183], v[164:167], v[72:75]
    buffer_load_dwordx4 v[180:183], v192, s[4:7], s24 offen offset:3072 sc1
    v_mfma_f32_16x16x32_bf16 v[76:79], v[184:187], v[164:167], v[76:79]
    buffer_load_dwordx2 v[164:165], v191, s[4:7], s23 offen sc1
    buffer_load_dwordx2 v[166:167], v191, s[4:7], s23 offen offset:512 sc1
    buffer_load_dwordx4 v[184:187], v241, s[4:7], s24 offen sc1
    s_add_u32 s23, s23, 4096
    s_add_u32 s24, s24, 40960
    s_waitcnt vmcnt(26) lgkmcnt(0)
    v_mfma_f32_16x16x32_bf16 v[0:3], v[96:99], v[80:83], v[0:3]
    v_mfma_f32_16x16x32_bf16 v[4:7], v[100:103], v[80:83], v[4:7]
    v_mfma_f32_16x16x32_bf16 v[8:11], v[104:107], v[80:83], v[8:11]
    v_mfma_f32_16x16x32_bf16 v[12:15], v[108:111], v[80:83], v[12:15]
    v_mfma_f32_16x16x32_bf16 v[16:19], v[112:115], v[80:83], v[16:19]
    buffer_load_dwordx2 v[80:81], v188, s[4:7], s23 offen sc1
    buffer_load_dwordx2 v[82:83], v188, s[4:7], s23 offen offset:512 sc1
    v_mfma_f32_16x16x32_bf16 v[20:23], v[96:99], v[84:87], v[20:23]
    v_mfma_f32_16x16x32_bf16 v[24:27], v[100:103], v[84:87], v[24:27]
    v_mfma_f32_16x16x32_bf16 v[28:31], v[104:107], v[84:87], v[28:31]
    v_mfma_f32_16x16x32_bf16 v[32:35], v[108:111], v[84:87], v[32:35]
    v_mfma_f32_16x16x32_bf16 v[36:39], v[112:115], v[84:87], v[36:39]
    buffer_load_dwordx2 v[84:85], v189, s[4:7], s23 offen sc1
    buffer_load_dwordx2 v[86:87], v189, s[4:7], s23 offen offset:512 sc1
    v_mfma_f32_16x16x32_bf16 v[40:43], v[96:99], v[88:91], v[40:43]
    v_mfma_f32_16x16x32_bf16 v[44:47], v[100:103], v[88:91], v[44:47]
    v_mfma_f32_16x16x32_bf16 v[48:51], v[104:107], v[88:91], v[48:51]
    v_mfma_f32_16x16x32_bf16 v[52:55], v[108:111], v[88:91], v[52:55]
    v_mfma_f32_16x16x32_bf16 v[56:59], v[112:115], v[88:91], v[56:59]
    buffer_load_dwordx2 v[88:89], v190, s[4:7], s23 offen sc1
    buffer_load_dwordx2 v[90:91], v190, s[4:7], s23 offen offset:512 sc1
    v_mfma_f32_16x16x32_bf16 v[60:63], v[96:99], v[92:95], v[60:63]
    buffer_load_dwordx4 v[96:99], v192, s[4:7], s24 offen sc1
    v_mfma_f32_16x16x32_bf16 v[64:67], v[100:103], v[92:95], v[64:67]
    buffer_load_dwordx4 v[100:103], v192, s[4:7], s24 offen offset:1024 sc1
    v_mfma_f32_16x16x32_bf16 v[68:71], v[104:107], v[92:95], v[68:71]
    buffer_load_dwordx4 v[104:107], v192, s[4:7], s24 offen offset:2048 sc1
    v_mfma_f32_16x16x32_bf16 v[72:75], v[108:111], v[92:95], v[72:75]
    buffer_load_dwordx4 v[108:111], v192, s[4:7], s24 offen offset:3072 sc1
    v_mfma_f32_16x16x32_bf16 v[76:79], v[112:115], v[92:95], v[76:79]
    buffer_load_dwordx2 v[92:93], v191, s[4:7], s23 offen sc1
    buffer_load_dwordx2 v[94:95], v191, s[4:7], s23 offen offset:512 sc1
    buffer_load_dwordx4 v[112:115], v241, s[4:7], s24 offen sc1
    s_add_u32 s23, s23, 4096
    s_add_u32 s24, s24, 40960
    s_waitcnt vmcnt(26) lgkmcnt(0)
    v_mfma_f32_16x16x32_bf16 v[0:3], v[132:135], v[116:119], v[0:3]
    v_mfma_f32_16x16x32_bf16 v[4:7], v[136:139], v[116:119], v[4:7]
    v_mfma_f32_16x16x32_bf16 v[8:11], v[140:143], v[116:119], v[8:11]
    v_mfma_f32_16x16x32_bf16 v[12:15], v[144:147], v[116:119], v[12:15]
    v_mfma_f32_16x16x32_bf16 v[16:19], v[148:151], v[116:119], v[16:19]
    buffer_load_dwordx2 v[116:117], v188, s[4:7], s23 offen sc1
    buffer_load_dwordx2 v[118:119], v188, s[4:7], s23 offen offset:512 sc1
    v_mfma_f32_16x16x32_bf16 v[20:23], v[132:135], v[120:123], v[20:23]
    v_mfma_f32_16x16x32_bf16 v[24:27], v[136:139], v[120:123], v[24:27]
    v_mfma_f32_16x16x32_bf16 v[28:31], v[140:143], v[120:123], v[28:31]
    v_mfma_f32_16x16x32_bf16 v[32:35], v[144:147], v[120:123], v[32:35]
    v_mfma_f32_16x16x32_bf16 v[36:39], v[148:151], v[120:123], v[36:39]
    buffer_load_dwordx2 v[120:121], v189, s[4:7], s23 offen sc1
    buffer_load_dwordx2 v[122:123], v189, s[4:7], s23 offen offset:512 sc1
    v_mfma_f32_16x16x32_bf16 v[40:43], v[132:135], v[124:127], v[40:43]
    v_mfma_f32_16x16x32_bf16 v[44:47], v[136:139], v[124:127], v[44:47]
    v_mfma_f32_16x16x32_bf16 v[48:51], v[140:143], v[124:127], v[48:51]
    v_mfma_f32_16x16x32_bf16 v[52:55], v[144:147], v[124:127], v[52:55]
    v_mfma_f32_16x16x32_bf16 v[56:59], v[148:151], v[124:127], v[56:59]
    buffer_load_dwordx2 v[124:125], v190, s[4:7], s23 offen sc1
    buffer_load_dwordx2 v[126:127], v190, s[4:7], s23 offen offset:512 sc1
    v_mfma_f32_16x16x32_bf16 v[60:63], v[132:135], v[128:131], v[60:63]
    buffer_load_dwordx4 v[132:135], v192, s[4:7], s24 offen sc1
    v_mfma_f32_16x16x32_bf16 v[64:67], v[136:139], v[128:131], v[64:67]
    buffer_load_dwordx4 v[136:139], v192, s[4:7], s24 offen offset:1024 sc1
    v_mfma_f32_16x16x32_bf16 v[68:71], v[140:143], v[128:131], v[68:71]
    buffer_load_dwordx4 v[140:143], v192, s[4:7], s24 offen offset:2048 sc1
    v_mfma_f32_16x16x32_bf16 v[72:75], v[144:147], v[128:131], v[72:75]
    buffer_load_dwordx4 v[144:147], v192, s[4:7], s24 offen offset:3072 sc1
    v_mfma_f32_16x16x32_bf16 v[76:79], v[148:151], v[128:131], v[76:79]
    buffer_load_dwordx2 v[128:129], v191, s[4:7], s23 offen sc1
    buffer_load_dwordx2 v[130:131], v191, s[4:7], s23 offen offset:512 sc1
    buffer_load_dwordx4 v[148:151], v241, s[4:7], s24 offen sc1
    s_add_u32 s23, s23, 4096
    s_add_u32 s24, s24, 40960
    s_waitcnt vmcnt(26) lgkmcnt(0)
    v_mfma_f32_16x16x32_bf16 v[0:3], v[168:171], v[152:155], v[0:3]
    v_mfma_f32_16x16x32_bf16 v[4:7], v[172:175], v[152:155], v[4:7]
    v_mfma_f32_16x16x32_bf16 v[8:11], v[176:179], v[152:155], v[8:11]
    v_mfma_f32_16x16x32_bf16 v[12:15], v[180:183], v[152:155], v[12:15]
    v_mfma_f32_16x16x32_bf16 v[16:19], v[184:187], v[152:155], v[16:19]
    v_mfma_f32_16x16x32_bf16 v[20:23], v[168:171], v[156:159], v[20:23]
    v_mfma_f32_16x16x32_bf16 v[24:27], v[172:175], v[156:159], v[24:27]
    v_mfma_f32_16x16x32_bf16 v[28:31], v[176:179], v[156:159], v[28:31]
    v_mfma_f32_16x16x32_bf16 v[32:35], v[180:183], v[156:159], v[32:35]
    v_mfma_f32_16x16x32_bf16 v[36:39], v[184:187], v[156:159], v[36:39]
    v_mfma_f32_16x16x32_bf16 v[40:43], v[168:171], v[160:163], v[40:43]
    v_mfma_f32_16x16x32_bf16 v[44:47], v[172:175], v[160:163], v[44:47]
    v_mfma_f32_16x16x32_bf16 v[48:51], v[176:179], v[160:163], v[48:51]
    v_mfma_f32_16x16x32_bf16 v[52:55], v[180:183], v[160:163], v[52:55]
    v_mfma_f32_16x16x32_bf16 v[56:59], v[184:187], v[160:163], v[56:59]
    v_mfma_f32_16x16x32_bf16 v[60:63], v[168:171], v[164:167], v[60:63]
    v_mfma_f32_16x16x32_bf16 v[64:67], v[172:175], v[164:167], v[64:67]
    v_mfma_f32_16x16x32_bf16 v[68:71], v[176:179], v[164:167], v[68:71]
    v_mfma_f32_16x16x32_bf16 v[72:75], v[180:183], v[164:167], v[72:75]
    v_mfma_f32_16x16x32_bf16 v[76:79], v[184:187], v[164:167], v[76:79]
    s_waitcnt vmcnt(13) lgkmcnt(0)
    v_mfma_f32_16x16x32_bf16 v[0:3], v[96:99], v[80:83], v[0:3]
    v_mfma_f32_16x16x32_bf16 v[4:7], v[100:103], v[80:83], v[4:7]
    v_mfma_f32_16x16x32_bf16 v[8:11], v[104:107], v[80:83], v[8:11]
    v_mfma_f32_16x16x32_bf16 v[12:15], v[108:111], v[80:83], v[12:15]
    v_mfma_f32_16x16x32_bf16 v[16:19], v[112:115], v[80:83], v[16:19]
    v_mfma_f32_16x16x32_bf16 v[20:23], v[96:99], v[84:87], v[20:23]
    v_mfma_f32_16x16x32_bf16 v[24:27], v[100:103], v[84:87], v[24:27]
    v_mfma_f32_16x16x32_bf16 v[28:31], v[104:107], v[84:87], v[28:31]
    v_mfma_f32_16x16x32_bf16 v[32:35], v[108:111], v[84:87], v[32:35]
    v_mfma_f32_16x16x32_bf16 v[36:39], v[112:115], v[84:87], v[36:39]
    v_mfma_f32_16x16x32_bf16 v[40:43], v[96:99], v[88:91], v[40:43]
    v_mfma_f32_16x16x32_bf16 v[44:47], v[100:103], v[88:91], v[44:47]
    v_mfma_f32_16x16x32_bf16 v[48:51], v[104:107], v[88:91], v[48:51]
    v_mfma_f32_16x16x32_bf16 v[52:55], v[108:111], v[88:91], v[52:55]
    v_mfma_f32_16x16x32_bf16 v[56:59], v[112:115], v[88:91], v[56:59]
    v_mfma_f32_16x16x32_bf16 v[60:63], v[96:99], v[92:95], v[60:63]
    v_mfma_f32_16x16x32_bf16 v[64:67], v[100:103], v[92:95], v[64:67]
    v_mfma_f32_16x16x32_bf16 v[68:71], v[104:107], v[92:95], v[68:71]
    v_mfma_f32_16x16x32_bf16 v[72:75], v[108:111], v[92:95], v[72:75]
    v_mfma_f32_16x16x32_bf16 v[76:79], v[112:115], v[92:95], v[76:79]
    s_waitcnt vmcnt(0) lgkmcnt(0)
    v_mfma_f32_16x16x32_bf16 v[0:3], v[132:135], v[116:119], v[0:3]
    v_mfma_f32_16x16x32_bf16 v[4:7], v[136:139], v[116:119], v[4:7]
    v_mfma_f32_16x16x32_bf16 v[8:11], v[140:143], v[116:119], v[8:11]
    v_mfma_f32_16x16x32_bf16 v[12:15], v[144:147], v[116:119], v[12:15]
    v_mfma_f32_16x16x32_bf16 v[16:19], v[148:151], v[116:119], v[16:19]
    v_mfma_f32_16x16x32_bf16 v[20:23], v[132:135], v[120:123], v[20:23]
    v_mfma_f32_16x16x32_bf16 v[24:27], v[136:139], v[120:123], v[24:27]
    v_mfma_f32_16x16x32_bf16 v[28:31], v[140:143], v[120:123], v[28:31]
    v_mfma_f32_16x16x32_bf16 v[32:35], v[144:147], v[120:123], v[32:35]
    v_mfma_f32_16x16x32_bf16 v[36:39], v[148:151], v[120:123], v[36:39]
    v_mfma_f32_16x16x32_bf16 v[40:43], v[132:135], v[124:127], v[40:43]
    v_mfma_f32_16x16x32_bf16 v[44:47], v[136:139], v[124:127], v[44:47]
    v_mfma_f32_16x16x32_bf16 v[48:51], v[140:143], v[124:127], v[48:51]
    v_mfma_f32_16x16x32_bf16 v[52:55], v[144:147], v[124:127], v[52:55]
    v_mfma_f32_16x16x32_bf16 v[56:59], v[148:151], v[124:127], v[56:59]
    v_mfma_f32_16x16x32_bf16 v[60:63], v[132:135], v[128:131], v[60:63]
    v_mfma_f32_16x16x32_bf16 v[64:67], v[136:139], v[128:131], v[64:67]
    v_mfma_f32_16x16x32_bf16 v[68:71], v[140:143], v[128:131], v[68:71]
    v_mfma_f32_16x16x32_bf16 v[72:75], v[144:147], v[128:131], v[72:75]
    v_mfma_f32_16x16x32_bf16 v[76:79], v[148:151], v[128:131], v[76:79]
    s_branch K2_FIN
K2_FIN:
    s_nop 7
    ds_write_b128 v238, v[20:23] offset:0
    ds_write_b128 v238, v[24:27] offset:1024
    ds_write_b128 v238, v[28:31] offset:2048
    ds_write_b128 v238, v[32:35] offset:3072
    ds_write_b128 v238, v[36:39] offset:4096
    ds_write_b128 v238, v[40:43] offset:5120
    ds_write_b128 v238, v[44:47] offset:6144
    ds_write_b128 v238, v[48:51] offset:7168
    ds_write_b128 v238, v[52:55] offset:8192
    ds_write_b128 v238, v[56:59] offset:9216
    ds_write_b128 v238, v[60:63] offset:10240
    ds_write_b128 v238, v[64:67] offset:11264
    ds_write_b128 v238, v[68:71] offset:12288
    ds_write_b128 v238, v[72:75] offset:13312
    ds_write_b128 v238, v[76:79] offset:14336
    v_lshlrev_b32 v196, 16, v216
    v_and_b32 v197, 0xffff0000, v216
    v_lshlrev_b32 v198, 16, v217
    v_and_b32 v199, 0xffff0000, v217
    v_lshlrev_b32 v200, 16, v218
    v_and_b32 v201, 0xffff0000, v218
    v_lshlrev_b32 v202, 16, v219
    v_and_b32 v203, 0xffff0000, v219
    v_lshlrev_b32 v204, 16, v220
    v_and_b32 v205, 0xffff0000, v220
    v_lshlrev_b32 v206, 16, v221
    v_and_b32 v207, 0xffff0000, v221
    v_lshlrev_b32 v208, 16, v222
    v_and_b32 v209, 0xffff0000, v222
    v_lshlrev_b32 v210, 16, v223
    v_and_b32 v211, 0xffff0000, v223
    v_lshlrev_b32 v212, 16, v224
    v_and_b32 v213, 0xffff0000, v224
    v_lshlrev_b32 v214, 16, v225
    v_and_b32 v215, 0xffff0000, v225
    s_lshl_b32 s26, s20, 2
    s_add_u32 s26, s26, 147488
    v_mov_b32 v226, s26
    v_mov_b32 v227, 1
    s_waitcnt lgkmcnt(0)
    ds_write_b32 v226, v227
    s_cmp_eq_u32 s20, 3
    s_cselect_b64 vcc, -1, 0
    v_cndmask_b32 v242, v195, v194, vcc
    s_cmp_eq_u32 s40, 3
    s_cselect_b64 vcc, -1, 0
    v_cndmask_b32 v243, v195, v194, vcc
    s_cmp_eq_u32 s41, 3
    s_cselect_b64 vcc, -1, 0
    v_cndmask_b32 v244, v195, v194, vcc
    s_cmp_eq_u32 s42, 3
    s_cselect_b64 vcc, -1, 0
    v_cndmask_b32 v245, v195, v194, vcc
    v_pk_mul_f32 v[0:1], v[0:1], v[242:243] op_sel_hi:[1,0]
    v_pk_fma_f32 v[0:1], v[196:197], v[194:195], v[0:1] op_sel:[0,1,0] op_sel_hi:[1,1,1]
    v_pk_mul_f32 v[2:3], v[2:3], v[242:243] op_sel_hi:[1,0]
    v_pk_fma_f32 v[2:3], v[198:199], v[194:195], v[2:3] op_sel:[0,1,0] op_sel_hi:[1,1,1]
    v_pk_mul_f32 v[4:5], v[4:5], v[242:243] op_sel_hi:[1,0]
    v_pk_fma_f32 v[4:5], v[200:201], v[194:195], v[4:5] op_sel:[0,1,0] op_sel_hi:[1,1,1]
    v_pk_mul_f32 v[6:7], v[6:7], v[242:243] op_sel_hi:[1,0]
    v_pk_fma_f32 v[6:7], v[202:203], v[194:195], v[6:7] op_sel:[0,1,0] op_sel_hi:[1,1,1]
    v_pk_mul_f32 v[8:9], v[8:9], v[242:243] op_sel_hi:[1,0]
    v_pk_fma_f32 v[8:9], v[204:205], v[194:195], v[8:9] op_sel:[0,1,0] op_sel_hi:[1,1,1]
    v_pk_mul_f32 v[10:11], v[10:11], v[242:243] op_sel_hi:[1,0]
    v_pk_fma_f32 v[10:11], v[206:207], v[194:195], v[10:11] op_sel:[0,1,0] op_sel_hi:[1,1,1]
    v_pk_mul_f32 v[12:13], v[12:13], v[242:243] op_sel_hi:[1,0]
    v_pk_fma_f32 v[12:13], v[208:209], v[194:195], v[12:13] op_sel:[0,1,0] op_sel_hi:[1,1,1]
    v_pk_mul_f32 v[14:15], v[14:15], v[242:243] op_sel_hi:[1,0]
    v_pk_fma_f32 v[14:15], v[210:211], v[194:195], v[14:15] op_sel:[0,1,0] op_sel_hi:[1,1,1]
    v_pk_mul_f32 v[16:17], v[16:17], v[242:243] op_sel_hi:[1,0]
    v_pk_fma_f32 v[16:17], v[212:213], v[194:195], v[16:17] op_sel:[0,1,0] op_sel_hi:[1,1,1]
    v_pk_mul_f32 v[18:19], v[18:19], v[242:243] op_sel_hi:[1,0]
    v_pk_fma_f32 v[18:19], v[214:215], v[194:195], v[18:19] op_sel:[0,1,0] op_sel_hi:[1,1,1]
    s_lshl_b32 s26, s40, 2
    s_add_u32 s26, s26, 147488
    v_mov_b32 v226, s26
    s_mov_b32 s50, 2097152
K_SPINR0_39:
    ds_read_b32 v227, v226
    s_sub_u32 s50, s50, 1
    s_cmp_eq_u32 s50, 0
    s_cbranch_scc1 K_SPINDR0_40
    s_waitcnt lgkmcnt(0)
    v_cmp_ne_u32 vcc, 1, v227
    s_nop 3
    s_cbranch_vccnz K_SPINR0_39
K_SPINDR0_40:
    s_waitcnt lgkmcnt(0)
    ds_read_b128 v[20:23], v235 offset:0
    ds_read_b128 v[24:27], v235 offset:1024
    ds_read_b128 v[28:31], v235 offset:2048
    ds_read_b128 v[32:35], v235 offset:3072
    ds_read_b128 v[36:39], v235 offset:4096
    s_waitcnt lgkmcnt(4)
    v_pk_fma_f32 v[0:1], v[20:21], v[242:243], v[0:1] op_sel:[0,1,0] op_sel_hi:[1,1,1]
    v_pk_fma_f32 v[2:3], v[22:23], v[242:243], v[2:3] op_sel:[0,1,0] op_sel_hi:[1,1,1]
    s_waitcnt lgkmcnt(3)
    v_pk_fma_f32 v[4:5], v[24:25], v[242:243], v[4:5] op_sel:[0,1,0] op_sel_hi:[1,1,1]
    v_pk_fma_f32 v[6:7], v[26:27], v[242:243], v[6:7] op_sel:[0,1,0] op_sel_hi:[1,1,1]
    s_waitcnt lgkmcnt(2)
    v_pk_fma_f32 v[8:9], v[28:29], v[242:243], v[8:9] op_sel:[0,1,0] op_sel_hi:[1,1,1]
    v_pk_fma_f32 v[10:11], v[30:31], v[242:243], v[10:11] op_sel:[0,1,0] op_sel_hi:[1,1,1]
    s_waitcnt lgkmcnt(1)
    v_pk_fma_f32 v[12:13], v[32:33], v[242:243], v[12:13] op_sel:[0,1,0] op_sel_hi:[1,1,1]
    v_pk_fma_f32 v[14:15], v[34:35], v[242:243], v[14:15] op_sel:[0,1,0] op_sel_hi:[1,1,1]
    s_waitcnt lgkmcnt(0)
    v_pk_fma_f32 v[16:17], v[36:37], v[242:243], v[16:17] op_sel:[0,1,0] op_sel_hi:[1,1,1]
    v_pk_fma_f32 v[18:19], v[38:39], v[242:243], v[18:19] op_sel:[0,1,0] op_sel_hi:[1,1,1]
    s_lshl_b32 s26, s41, 2
    s_add_u32 s26, s26, 147488
    v_mov_b32 v226, s26
    s_mov_b32 s50, 2097152
K_SPINR1_41:
    ds_read_b32 v227, v226
    s_sub_u32 s50, s50, 1
    s_cmp_eq_u32 s50, 0
    s_cbranch_scc1 K_SPINDR1_42
    s_waitcnt lgkmcnt(0)
    v_cmp_ne_u32 vcc, 1, v227
    s_nop 3
    s_cbranch_vccnz K_SPINR1_41
K_SPINDR1_42:
    s_waitcnt lgkmcnt(0)
    ds_read_b128 v[40:43], v236 offset:0
    ds_read_b128 v[44:47], v236 offset:1024
    ds_read_b128 v[48:51], v236 offset:2048
    ds_read_b128 v[52:55], v236 offset:3072
    ds_read_b128 v[56:59], v236 offset:4096
    s_waitcnt lgkmcnt(4)
    v_pk_fma_f32 v[0:1], v[40:41], v[244:245], v[0:1] op_sel_hi:[1,0,1]
    v_pk_fma_f32 v[2:3], v[42:43], v[244:245], v[2:3] op_sel_hi:[1,0,1]
    s_waitcnt lgkmcnt(3)
    v_pk_fma_f32 v[4:5], v[44:45], v[244:245], v[4:5] op_sel_hi:[1,0,1]
    v_pk_fma_f32 v[6:7], v[46:47], v[244:245], v[6:7] op_sel_hi:[1,0,1]
    s_waitcnt lgkmcnt(2)
    v_pk_fma_f32 v[8:9], v[48:49], v[244:245], v[8:9] op_sel_hi:[1,0,1]
    v_pk_fma_f32 v[10:11], v[50:51], v[244:245], v[10:11] op_sel_hi:[1,0,1]
    s_waitcnt lgkmcnt(1)
    v_pk_fma_f32 v[12:13], v[52:53], v[244:245], v[12:13] op_sel_hi:[1,0,1]
    v_pk_fma_f32 v[14:15], v[54:55], v[244:245], v[14:15] op_sel_hi:[1,0,1]
    s_waitcnt lgkmcnt(0)
    v_pk_fma_f32 v[16:17], v[56:57], v[244:245], v[16:17] op_sel_hi:[1,0,1]
    v_pk_fma_f32 v[18:19], v[58:59], v[244:245], v[18:19] op_sel_hi:[1,0,1]
    s_lshl_b32 s26, s42, 2
    s_add_u32 s26, s26, 147488
    v_mov_b32 v226, s26
    s_mov_b32 s50, 2097152
K_SPINR2_43:
    ds_read_b32 v227, v226
    s_sub_u32 s50, s50, 1
    s_cmp_eq_u32 s50, 0
    s_cbranch_scc1 K_SPINDR2_44
    s_waitcnt lgkmcnt(0)
    v_cmp_ne_u32 vcc, 1, v227
    s_nop 3
    s_cbranch_vccnz K_SPINR2_43
K_SPINDR2_44:
    s_waitcnt lgkmcnt(0)
    ds_read_b128 v[60:63], v237 offset:0
    ds_read_b128 v[64:67], v237 offset:1024
    ds_read_b128 v[68:71], v237 offset:2048
    ds_read_b128 v[72:75], v237 offset:3072
    ds_read_b128 v[76:79], v237 offset:4096
    s_waitcnt lgkmcnt(4)
    v_pk_fma_f32 v[0:1], v[60:61], v[244:245], v[0:1] op_sel:[0,1,0] op_sel_hi:[1,1,1]
    v_pk_fma_f32 v[2:3], v[62:63], v[244:245], v[2:3] op_sel:[0,1,0] op_sel_hi:[1,1,1]
    s_waitcnt lgkmcnt(3)
    v_pk_fma_f32 v[4:5], v[64:65], v[244:245], v[4:5] op_sel:[0,1,0] op_sel_hi:[1,1,1]
    v_pk_fma_f32 v[6:7], v[66:67], v[244:245], v[6:7] op_sel:[0,1,0] op_sel_hi:[1,1,1]
    s_waitcnt lgkmcnt(2)
    v_pk_fma_f32 v[8:9], v[68:69], v[244:245], v[8:9] op_sel:[0,1,0] op_sel_hi:[1,1,1]
    v_pk_fma_f32 v[10:11], v[70:71], v[244:245], v[10:11] op_sel:[0,1,0] op_sel_hi:[1,1,1]
    s_waitcnt lgkmcnt(1)
    v_pk_fma_f32 v[12:13], v[72:73], v[244:245], v[12:13] op_sel:[0,1,0] op_sel_hi:[1,1,1]
    v_pk_fma_f32 v[14:15], v[74:75], v[244:245], v[14:15] op_sel:[0,1,0] op_sel_hi:[1,1,1]
    s_waitcnt lgkmcnt(0)
    v_pk_fma_f32 v[16:17], v[76:77], v[244:245], v[16:17] op_sel:[0,1,0] op_sel_hi:[1,1,1]
    v_pk_fma_f32 v[18:19], v[78:79], v[244:245], v[18:19] op_sel:[0,1,0] op_sel_hi:[1,1,1]
    v_cvt_pk_bf16_f32 v246, v0, v1
    v_cvt_pk_bf16_f32 v247, v2, v3
    buffer_store_dwordx2 v[246:247], v234, s[12:15], 0 offen offset:0
    v_cvt_pk_bf16_f32 v248, v4, v5
    v_cvt_pk_bf16_f32 v249, v6, v7
    buffer_store_dwordx2 v[248:249], v234, s[12:15], 0 offen offset:32
    v_cvt_pk_bf16_f32 v250, v8, v9
    v_cvt_pk_bf16_f32 v251, v10, v11
    buffer_store_dwordx2 v[250:251], v234, s[12:15], 0 offen offset:64
    v_cvt_pk_bf16_f32 v252, v12, v13
    v_cvt_pk_bf16_f32 v253, v14, v15
    buffer_store_dwordx2 v[252:253], v234, s[12:15], 0 offen offset:96
    v_cvt_pk_bf16_f32 v254, v16, v17
    v_cvt_pk_bf16_f32 v255, v18, v19
    buffer_store_dwordx2 v[254:255], v234, s[12:15], 0 offen offset:128
K_FIN:
K_END:
    s_endpgm
K_CODE_END:
.section .rodata,"a"
.p2align 6
.amdhsa_kernel gated_mix__sliding_local_dilated__dense_activation_gelu__prompt_kernel
  .amdhsa_next_free_vgpr 256
  .amdhsa_next_free_sgpr 102
  .amdhsa_accum_offset 256
  .amdhsa_group_segment_fixed_size 0
  .amdhsa_kernarg_size 96
  .amdhsa_user_sgpr_count 2
  .amdhsa_user_sgpr_kernarg_segment_ptr 1
  .amdhsa_system_sgpr_workgroup_id_x 1
.end_amdhsa_kernel
```
